```python
import torch

def _softmax(x, axis=-1):
    return torch.softmax(x, dim=axis)
def _gelu(x):
    return torch.nn.functional.gelu(x, approximate="tanh")
def _silu(x):
    return torch.nn.functional.silu(x)
def _sigmoid(x):
    return torch.sigmoid(x)
def _layernorm(x, axis=-1, eps=1e-5):
    m = x.mean(dim=axis, keepdim=True)
    v = x.var(dim=axis, keepdim=True, unbiased=False)
    return (x - m) / torch.sqrt(v + eps)
def _scatter_add(tgt, idx, src, axis=0):
    return tgt.clone().index_add_(axis, idx, src)
def _segment_sum(src, seg, n):
    out = torch.zeros((n,) + src.shape[1:], dtype=src.dtype)
    return out.index_add_(0, seg, src)
def _pad(x, pw):
    flat = tuple(v for pair in reversed(pw) for v in pair)
    return torch.nn.functional.pad(x, flat)

kernel_name = 'gated_mix__gqa_block_cached__glu_gated_geglu__decode'

def setup_inputs():

    _w = (lambda a: (lambda t: t.to(torch.bfloat16) if t.is_floating_point() else t)(torch.as_tensor(a)))
    def _A_setup():
        B, Sq, D = 2, 1, 576
        Hq, Hkv, Sk, Dh = 32, 16, 32768, 128
        assert Hq % Hkv == 0, (Hq, Hkv)
        return {
            "x": _w((lambda *s: torch.randn(*s, dtype=torch.bfloat16) * 0.05)(B, Sq, D)),
            "k_cache": _w((lambda *s: torch.randn(*s, dtype=torch.bfloat16) * 6.4)(B, Hkv, Sk, Dh)),
            "v_cache": _w((lambda *s: torch.randn(*s, dtype=torch.bfloat16) * 0.05)(B, Hkv, Sk, Dh)),
            "wq": _w((lambda *s: torch.randn(*s, dtype=torch.bfloat16) * 6.4)(D, Hq * Dh) * (D ** -0.5)),
            "wo": _w((lambda *s: torch.randn(*s, dtype=torch.bfloat16) * 0.05)(Hq * Dh, D) * ((Hq * Dh) ** -0.5)),
        }
    _A_in = _A_setup()

    def _B_setup():
        B, S, Dm, Df = 2, 1, 576, 4608
        return {
            "x": _w((lambda *s: torch.randn(*s, dtype=torch.bfloat16) * 0.05)(B, S, Dm)),
            "w_gate": _w((lambda *s: torch.randn(*s, dtype=torch.bfloat16) * 0.4)(Dm, Df) * (Dm ** -0.5)),
            "w_up": _w((lambda *s: torch.randn(*s, dtype=torch.bfloat16) * 0.4)(Dm, Df) * (Dm ** -0.5)),
            "w_down": _w((lambda *s: torch.randn(*s, dtype=torch.bfloat16) * 0.4)(Df, Dm) * (Df ** -0.5)),
        }
    _B_in = _B_setup()

    return {
        "A_x": _A_in["x"],
        "A_k_cache": _A_in["k_cache"],
        "A_v_cache": _A_in["v_cache"],
        "A_wq": _A_in["wq"],
        "A_wo": _A_in["wo"],
        "B_x": _B_in["x"],
        "B_w_gate": _B_in["w_gate"],
        "B_w_up": _B_in["w_up"],
        "B_w_down": _B_in["w_down"],
        "gate_w": _w((lambda *s: torch.randn(*s, dtype=torch.bfloat16) * 0.05)(576) * 16.0),
    }

def reference(A_x, A_k_cache, A_v_cache, A_wq, A_wo, B_x, B_w_gate, B_w_up, B_w_down, gate_w):
    def _A_ref(x, k_cache, v_cache, wq, wo):
        B, Sq, D = x.shape
        Hq, Dh = 32, 128
        Hkv = k_cache.shape[1]
        rep = Hq // Hkv
        q = (lambda x, *d: x.permute(*d))((x @ wq).reshape(B, Sq, Hq, Dh), 0, 2, 1, 3)
        k = (lambda x, n, axis: torch.repeat_interleave(x, n, dim=axis))(k_cache, rep, axis=1)
        v = (lambda x, n, axis: torch.repeat_interleave(x, n, dim=axis))(v_cache, rep, axis=1)
        scores = torch.einsum("bhqd,bhkd->bhqk", q, k) * (Dh ** -0.5)
        p = _softmax(scores, axis=-1)
        o = torch.einsum("bhqk,bhkd->bhqd", p, v)
        return (lambda x, *d: x.permute(*d))(o, 0, 2, 1, 3).reshape(B, Sq, Hq * Dh) @ wo

    def _B_ref(x, w_gate, w_up, w_down):
        g = torch.einsum("bsd,df->bsf", x, w_gate)
        u = torch.einsum("bsd,df->bsf", x, w_up)
        h = _gelu(g) * u
        return torch.einsum("bsf,fd->bsd", h, w_down)

    x = A_x
    g = _sigmoid((x * gate_w).sum(-1, keepdims=True))
    a = _A_ref(x, A_k_cache, A_v_cache, A_wq, A_wo)
    b = _B_ref(x, B_w_gate, B_w_up, B_w_down)
    return g * a + (1 - g) * b
```

```asm
; @launch kernel=qproj_kernel grid=(192,1,1) block=(256,1,1) lds=16384
; @launch kernel=gated_mix__gqa_block_cached__glu_gated_geglu__decode_kernel grid=(328,1,1) block=(512,1,1) lds=67584
; @launch kernel=oproj_kernel grid=(288,1,1) block=(256,1,1) lds=17408
.amdgcn_target "amdgcn-amd-amdhsa--gfx950"
.text

.globl qproj_kernel
.p2align 8
.type qproj_kernel,@function
qproj_kernel:
    s_cmp_ge_u32 s2, 192
    s_cbranch_scc1 Lq_end
    s_load_dwordx2 s[4:5], s[0:1], 0
    s_load_dwordx2 s[6:7], s[0:1], 24
    s_load_dwordx2 s[8:9], s[0:1], 96
    s_and_b32 s10, s2, 63
    s_lshr_b32 s11, s2, 6
    v_and_b32 v1, 63, v0
    v_lshrrev_b32 v2, 6, v0
    v_lshrrev_b32 v3, 3, v1
    v_and_b32 v4, 7, v1
    v_mul_u32_u24 v5, 48, v2
    v_add_u32 v5, v5, v3
    s_mul_i32 s12, s11, 192
    v_add_u32 v5, s12, v5
    v_lshlrev_b32 v6, 13, v5
    v_lshlrev_b32 v7, 4, v4
    v_add_u32 v6, v6, v7
    s_lshl_b32 s13, s10, 7
    v_add_u32 v6, s13, v6
    v_lshlrev_b32 v7, 1, v5
    s_waitcnt lgkmcnt(0)
    global_load_dwordx4 v[16:19], v6, s[6:7]
    v_add_u32 v6, 0x10000, v6
    global_load_ushort v40, v7, s[4:5] offset:0
    global_load_ushort v41, v7, s[4:5] offset:1152
    global_load_dwordx4 v[20:23], v6, s[6:7]
    v_add_u32 v6, 0x10000, v6
    global_load_ushort v42, v7, s[4:5] offset:16
    global_load_ushort v43, v7, s[4:5] offset:1168
    global_load_dwordx4 v[24:27], v6, s[6:7]
    v_add_u32 v6, 0x10000, v6
    global_load_ushort v44, v7, s[4:5] offset:32
    global_load_ushort v45, v7, s[4:5] offset:1184
    global_load_dwordx4 v[28:31], v6, s[6:7]
    v_add_u32 v6, 0x10000, v6
    global_load_ushort v46, v7, s[4:5] offset:48
    global_load_ushort v47, v7, s[4:5] offset:1200
    global_load_dwordx4 v[32:35], v6, s[6:7]
    v_add_u32 v6, 0x10000, v6
    global_load_ushort v48, v7, s[4:5] offset:64
    global_load_ushort v49, v7, s[4:5] offset:1216
    global_load_dwordx4 v[36:39], v6, s[6:7]
    v_add_u32 v6, 0x10000, v6
    global_load_ushort v50, v7, s[4:5] offset:80
    global_load_ushort v51, v7, s[4:5] offset:1232
    v_mov_b32 v60, 0
    v_mov_b32 v61, 0
    v_mov_b32 v62, 0
    v_mov_b32 v63, 0
    v_mov_b32 v64, 0
    v_mov_b32 v65, 0
    v_mov_b32 v66, 0
    v_mov_b32 v67, 0
    v_mov_b32 v68, 0
    v_mov_b32 v69, 0
    v_mov_b32 v70, 0
    v_mov_b32 v71, 0
    v_mov_b32 v72, 0
    v_mov_b32 v73, 0
    v_mov_b32 v74, 0
    v_mov_b32 v75, 0
    s_waitcnt vmcnt(15)
    v_lshlrev_b32 v40, 16, v40
    v_lshlrev_b32 v41, 16, v41
    v_lshlrev_b32 v52, 16, v16
    v_and_b32 v53, 0xffff0000, v16
    v_lshlrev_b32 v54, 16, v17
    v_and_b32 v55, 0xffff0000, v17
    v_lshlrev_b32 v56, 16, v18
    v_and_b32 v57, 0xffff0000, v18
    v_lshlrev_b32 v58, 16, v19
    v_and_b32 v59, 0xffff0000, v19
    v_fmac_f32 v60, v40, v52
    v_fmac_f32 v61, v40, v53
    v_fmac_f32 v62, v40, v54
    v_fmac_f32 v63, v40, v55
    v_fmac_f32 v64, v40, v56
    v_fmac_f32 v65, v40, v57
    v_fmac_f32 v66, v40, v58
    v_fmac_f32 v67, v40, v59
    v_fmac_f32 v68, v41, v52
    v_fmac_f32 v69, v41, v53
    v_fmac_f32 v70, v41, v54
    v_fmac_f32 v71, v41, v55
    v_fmac_f32 v72, v41, v56
    v_fmac_f32 v73, v41, v57
    v_fmac_f32 v74, v41, v58
    v_fmac_f32 v75, v41, v59
    s_waitcnt vmcnt(12)
    v_lshlrev_b32 v42, 16, v42
    v_lshlrev_b32 v43, 16, v43
    v_lshlrev_b32 v52, 16, v20
    v_and_b32 v53, 0xffff0000, v20
    v_lshlrev_b32 v54, 16, v21
    v_and_b32 v55, 0xffff0000, v21
    v_lshlrev_b32 v56, 16, v22
    v_and_b32 v57, 0xffff0000, v22
    v_lshlrev_b32 v58, 16, v23
    v_and_b32 v59, 0xffff0000, v23
    v_fmac_f32 v60, v42, v52
    v_fmac_f32 v61, v42, v53
    v_fmac_f32 v62, v42, v54
    v_fmac_f32 v63, v42, v55
    v_fmac_f32 v64, v42, v56
    v_fmac_f32 v65, v42, v57
    v_fmac_f32 v66, v42, v58
    v_fmac_f32 v67, v42, v59
    v_fmac_f32 v68, v43, v52
    v_fmac_f32 v69, v43, v53
    v_fmac_f32 v70, v43, v54
    v_fmac_f32 v71, v43, v55
    v_fmac_f32 v72, v43, v56
    v_fmac_f32 v73, v43, v57
    v_fmac_f32 v74, v43, v58
    v_fmac_f32 v75, v43, v59
    s_waitcnt vmcnt(9)
    v_lshlrev_b32 v44, 16, v44
    v_lshlrev_b32 v45, 16, v45
    v_lshlrev_b32 v52, 16, v24
    v_and_b32 v53, 0xffff0000, v24
    v_lshlrev_b32 v54, 16, v25
    v_and_b32 v55, 0xffff0000, v25
    v_lshlrev_b32 v56, 16, v26
    v_and_b32 v57, 0xffff0000, v26
    v_lshlrev_b32 v58, 16, v27
    v_and_b32 v59, 0xffff0000, v27
    v_fmac_f32 v60, v44, v52
    v_fmac_f32 v61, v44, v53
    v_fmac_f32 v62, v44, v54
    v_fmac_f32 v63, v44, v55
    v_fmac_f32 v64, v44, v56
    v_fmac_f32 v65, v44, v57
    v_fmac_f32 v66, v44, v58
    v_fmac_f32 v67, v44, v59
    v_fmac_f32 v68, v45, v52
    v_fmac_f32 v69, v45, v53
    v_fmac_f32 v70, v45, v54
    v_fmac_f32 v71, v45, v55
    v_fmac_f32 v72, v45, v56
    v_fmac_f32 v73, v45, v57
    v_fmac_f32 v74, v45, v58
    v_fmac_f32 v75, v45, v59
    s_waitcnt vmcnt(6)
    v_lshlrev_b32 v46, 16, v46
    v_lshlrev_b32 v47, 16, v47
    v_lshlrev_b32 v52, 16, v28
    v_and_b32 v53, 0xffff0000, v28
    v_lshlrev_b32 v54, 16, v29
    v_and_b32 v55, 0xffff0000, v29
    v_lshlrev_b32 v56, 16, v30
    v_and_b32 v57, 0xffff0000, v30
    v_lshlrev_b32 v58, 16, v31
    v_and_b32 v59, 0xffff0000, v31
    v_fmac_f32 v60, v46, v52
    v_fmac_f32 v61, v46, v53
    v_fmac_f32 v62, v46, v54
    v_fmac_f32 v63, v46, v55
    v_fmac_f32 v64, v46, v56
    v_fmac_f32 v65, v46, v57
    v_fmac_f32 v66, v46, v58
    v_fmac_f32 v67, v46, v59
    v_fmac_f32 v68, v47, v52
    v_fmac_f32 v69, v47, v53
    v_fmac_f32 v70, v47, v54
    v_fmac_f32 v71, v47, v55
    v_fmac_f32 v72, v47, v56
    v_fmac_f32 v73, v47, v57
    v_fmac_f32 v74, v47, v58
    v_fmac_f32 v75, v47, v59
    s_waitcnt vmcnt(3)
    v_lshlrev_b32 v48, 16, v48
    v_lshlrev_b32 v49, 16, v49
    v_lshlrev_b32 v52, 16, v32
    v_and_b32 v53, 0xffff0000, v32
    v_lshlrev_b32 v54, 16, v33
    v_and_b32 v55, 0xffff0000, v33
    v_lshlrev_b32 v56, 16, v34
    v_and_b32 v57, 0xffff0000, v34
    v_lshlrev_b32 v58, 16, v35
    v_and_b32 v59, 0xffff0000, v35
    v_fmac_f32 v60, v48, v52
    v_fmac_f32 v61, v48, v53
    v_fmac_f32 v62, v48, v54
    v_fmac_f32 v63, v48, v55
    v_fmac_f32 v64, v48, v56
    v_fmac_f32 v65, v48, v57
    v_fmac_f32 v66, v48, v58
    v_fmac_f32 v67, v48, v59
    v_fmac_f32 v68, v49, v52
    v_fmac_f32 v69, v49, v53
    v_fmac_f32 v70, v49, v54
    v_fmac_f32 v71, v49, v55
    v_fmac_f32 v72, v49, v56
    v_fmac_f32 v73, v49, v57
    v_fmac_f32 v74, v49, v58
    v_fmac_f32 v75, v49, v59
    s_waitcnt vmcnt(0)
    v_lshlrev_b32 v50, 16, v50
    v_lshlrev_b32 v51, 16, v51
    v_lshlrev_b32 v52, 16, v36
    v_and_b32 v53, 0xffff0000, v36
    v_lshlrev_b32 v54, 16, v37
    v_and_b32 v55, 0xffff0000, v37
    v_lshlrev_b32 v56, 16, v38
    v_and_b32 v57, 0xffff0000, v38
    v_lshlrev_b32 v58, 16, v39
    v_and_b32 v59, 0xffff0000, v39
    v_fmac_f32 v60, v50, v52
    v_fmac_f32 v61, v50, v53
    v_fmac_f32 v62, v50, v54
    v_fmac_f32 v63, v50, v55
    v_fmac_f32 v64, v50, v56
    v_fmac_f32 v65, v50, v57
    v_fmac_f32 v66, v50, v58
    v_fmac_f32 v67, v50, v59
    v_fmac_f32 v68, v51, v52
    v_fmac_f32 v69, v51, v53
    v_fmac_f32 v70, v51, v54
    v_fmac_f32 v71, v51, v55
    v_fmac_f32 v72, v51, v56
    v_fmac_f32 v73, v51, v57
    v_fmac_f32 v74, v51, v58
    v_fmac_f32 v75, v51, v59
    v_lshlrev_b32 v8, 6, v0
    ds_write_b128 v8, v[60:63] offset:0
    ds_write_b128 v8, v[64:67] offset:16
    ds_write_b128 v8, v[68:71] offset:32
    ds_write_b128 v8, v[72:75] offset:48
    s_waitcnt lgkmcnt(0)
    s_barrier
    v_cmp_gt_u32 vcc, 128, v0
    s_nop 0
    s_and_saveexec_b64 s[14:15], vcc
    s_cbranch_execz Lq_end
    v_lshrrev_b32 v9, 6, v0
    v_and_b32 v10, 63, v0
    v_lshrrev_b32 v11, 3, v10
    v_and_b32 v12, 7, v10
    v_lshlrev_b32 v11, 6, v11
    v_lshl_add_u32 v12, v9, 3, v12
    v_lshl_add_u32 v11, v12, 2, v11
    v_mov_b32 v13, 0
    ds_read_b32 v20, v11 offset:0
    ds_read_b32 v21, v11 offset:512
    ds_read_b32 v22, v11 offset:1024
    ds_read_b32 v23, v11 offset:1536
    ds_read_b32 v24, v11 offset:2048
    ds_read_b32 v25, v11 offset:2560
    ds_read_b32 v26, v11 offset:3072
    ds_read_b32 v27, v11 offset:3584
    ds_read_b32 v28, v11 offset:4096
    ds_read_b32 v29, v11 offset:4608
    ds_read_b32 v30, v11 offset:5120
    ds_read_b32 v31, v11 offset:5632
    ds_read_b32 v32, v11 offset:6144
    ds_read_b32 v33, v11 offset:6656
    ds_read_b32 v34, v11 offset:7168
    ds_read_b32 v35, v11 offset:7680
    ds_read_b32 v36, v11 offset:8192
    ds_read_b32 v37, v11 offset:8704
    ds_read_b32 v38, v11 offset:9216
    ds_read_b32 v39, v11 offset:9728
    ds_read_b32 v40, v11 offset:10240
    ds_read_b32 v41, v11 offset:10752
    ds_read_b32 v42, v11 offset:11264
    ds_read_b32 v43, v11 offset:11776
    ds_read_b32 v44, v11 offset:12288
    ds_read_b32 v45, v11 offset:12800
    ds_read_b32 v46, v11 offset:13312
    ds_read_b32 v47, v11 offset:13824
    ds_read_b32 v48, v11 offset:14336
    ds_read_b32 v49, v11 offset:14848
    ds_read_b32 v50, v11 offset:15360
    ds_read_b32 v51, v11 offset:15872
    s_waitcnt lgkmcnt(0)
    v_add_f32 v13, v13, v20
    v_add_f32 v13, v13, v21
    v_add_f32 v13, v13, v22
    v_add_f32 v13, v13, v23
    v_add_f32 v13, v13, v24
    v_add_f32 v13, v13, v25
    v_add_f32 v13, v13, v26
    v_add_f32 v13, v13, v27
    v_add_f32 v13, v13, v28
    v_add_f32 v13, v13, v29
    v_add_f32 v13, v13, v30
    v_add_f32 v13, v13, v31
    v_add_f32 v13, v13, v32
    v_add_f32 v13, v13, v33
    v_add_f32 v13, v13, v34
    v_add_f32 v13, v13, v35
    v_add_f32 v13, v13, v36
    v_add_f32 v13, v13, v37
    v_add_f32 v13, v13, v38
    v_add_f32 v13, v13, v39
    v_add_f32 v13, v13, v40
    v_add_f32 v13, v13, v41
    v_add_f32 v13, v13, v42
    v_add_f32 v13, v13, v43
    v_add_f32 v13, v13, v44
    v_add_f32 v13, v13, v45
    v_add_f32 v13, v13, v46
    v_add_f32 v13, v13, v47
    v_add_f32 v13, v13, v48
    v_add_f32 v13, v13, v49
    v_add_f32 v13, v13, v50
    v_add_f32 v13, v13, v51
    s_lshl_b32 s16, s11, 1
    v_add_u32 v14, s16, v9
    v_lshlrev_b32 v14, 12, v14
    v_add_u32 v14, v14, v10
    s_lshl_b32 s17, s10, 6
    v_add_u32 v14, s17, v14
    v_lshlrev_b32 v14, 2, v14
    global_store_dword v14, v13, s[8:9] offset:0
Lq_end:
    s_endpgm
.section .rodata,"a"
.p2align 6
.amdhsa_kernel qproj_kernel
  .amdhsa_next_free_vgpr 80
  .amdhsa_next_free_sgpr 64
  .amdhsa_accum_offset 80
  .amdhsa_group_segment_fixed_size 0
  .amdhsa_kernarg_size 104
  .amdhsa_user_sgpr_count 2
  .amdhsa_user_sgpr_kernarg_segment_ptr 1
  .amdhsa_system_sgpr_workgroup_id_x 1
.end_amdhsa_kernel
.text
.globl gated_mix__gqa_block_cached__glu_gated_geglu__decode_kernel
.p2align 8
.type gated_mix__gqa_block_cached__glu_gated_geglu__decode_kernel,@function
gated_mix__gqa_block_cached__glu_gated_geglu__decode_kernel:
    s_cmp_ge_u32 s2, 328
    s_cbranch_scc1 La_end
    s_load_dwordx2 s[8:9], s[0:1], 96
    s_cmp_ge_u32 s2, 256
    s_cbranch_scc1 Lffn
    s_load_dwordx2 s[4:5], s[0:1], 8
    s_load_dwordx2 s[6:7], s[0:1], 16
    v_and_b32 v1, 63, v0
    v_lshlrev_b32 v2, 4, v1
    v_lshrrev_b32 v3, 6, v0
    s_nop 0
    v_readfirstlane_b32 s10, v3
    s_lshr_b32 s11, s2, 3
    s_and_b32 s12, s2, 7
    s_lshl_b32 s13, s11, 23
    s_lshl_b32 s14, s12, 20
    s_add_u32 s13, s13, s14
    s_lshl_b32 s14, s10, 12
    s_add_u32 s13, s13, s14
    s_mov_b32 s20, 0x3e0293ee
    s_lshr_b32 s15, s11, 4
    s_and_b32 s16, s11, 15
    s_lshl_b32 s15, s15, 14
    s_lshl_b32 s16, s16, 10
    s_add_u32 s15, s15, s16
    v_and_b32 v4, 15, v1
    v_lshlrev_b32 v4, 5, v4
    s_waitcnt lgkmcnt(0)
    s_add_u32 s4, s4, s13
    s_addc_u32 s5, s5, 0
    s_add_u32 s6, s6, s13
    s_addc_u32 s7, s7, 0
    s_add_u32 s18, s8, s15
    s_addc_u32 s19, s9, 0
    global_load_dwordx4 v[8:11], v4, s[18:19] offset:0
    global_load_dwordx4 v[12:15], v4, s[18:19] offset:16
    global_load_dwordx4 v[16:19], v4, s[18:19] offset:512
    global_load_dwordx4 v[20:23], v4, s[18:19] offset:528
    v_add_u32 v4, 0x8000, v4
    global_load_dwordx4 v[104:107], v4, s[18:19] offset:0
    global_load_dwordx4 v[108:111], v4, s[18:19] offset:16
    global_load_dwordx4 v[112:115], v4, s[18:19] offset:512
    global_load_dwordx4 v[116:119], v4, s[18:19] offset:528
    v_add_u32 v4, 0x8000, v4
    global_load_dwordx4 v[24:27], v4, s[18:19] offset:0
    global_load_dwordx4 v[28:31], v4, s[18:19] offset:16
    global_load_dwordx4 v[120:123], v4, s[18:19] offset:512
    global_load_dwordx4 v[124:127], v4, s[18:19] offset:528
    global_load_dwordx4 v[32:35], v2, s[4:5] offset:0 nt
    global_load_dwordx4 v[36:39], v2, s[4:5] offset:1024 nt
    global_load_dwordx4 v[40:43], v2, s[4:5] offset:2048 nt
    global_load_dwordx4 v[44:47], v2, s[4:5] offset:3072 nt
    global_load_dwordx4 v[48:51], v2, s[6:7] offset:0 nt
    global_load_dwordx4 v[52:55], v2, s[6:7] offset:1024 nt
    global_load_dwordx4 v[56:59], v2, s[6:7] offset:2048 nt
    global_load_dwordx4 v[60:63], v2, s[6:7] offset:3072 nt
    s_add_u32 s4, s4, 32768
    s_addc_u32 s5, s5, 0
    s_add_u32 s6, s6, 32768
    s_addc_u32 s7, s7, 0
    global_load_dwordx4 v[64:67], v2, s[4:5] offset:0 nt
    global_load_dwordx4 v[68:71], v2, s[4:5] offset:1024 nt
    global_load_dwordx4 v[72:75], v2, s[4:5] offset:2048 nt
    global_load_dwordx4 v[76:79], v2, s[4:5] offset:3072 nt
    global_load_dwordx4 v[80:83], v2, s[6:7] offset:0 nt
    global_load_dwordx4 v[84:87], v2, s[6:7] offset:1024 nt
    global_load_dwordx4 v[88:91], v2, s[6:7] offset:2048 nt
    global_load_dwordx4 v[92:95], v2, s[6:7] offset:3072 nt
    s_add_u32 s4, s4, 32768
    s_addc_u32 s5, s5, 0
    s_add_u32 s6, s6, 32768
    s_addc_u32 s7, s7, 0
    global_load_dwordx4 v[128:131], v2, s[4:5] offset:0 nt
    global_load_dwordx4 v[132:135], v2, s[4:5] offset:1024 nt
    global_load_dwordx4 v[136:139], v2, s[4:5] offset:2048 nt
    global_load_dwordx4 v[140:143], v2, s[4:5] offset:3072 nt
    global_load_dwordx4 v[144:147], v2, s[6:7] offset:0 nt
    global_load_dwordx4 v[148:151], v2, s[6:7] offset:1024 nt
    global_load_dwordx4 v[152:155], v2, s[6:7] offset:2048 nt
    global_load_dwordx4 v[156:159], v2, s[6:7] offset:3072 nt
    s_add_u32 s4, s4, 32768
    s_addc_u32 s5, s5, 0
    s_add_u32 s6, s6, 32768
    s_addc_u32 s7, s7, 0
    s_waitcnt vmcnt(24)
    v_add_f32 v8, v8, v104
    v_add_f32 v9, v9, v105
    v_add_f32 v10, v10, v106
    v_add_f32 v11, v11, v107
    v_add_f32 v12, v12, v108
    v_add_f32 v13, v13, v109
    v_add_f32 v14, v14, v110
    v_add_f32 v15, v15, v111
    v_add_f32 v16, v16, v112
    v_add_f32 v17, v17, v113
    v_add_f32 v18, v18, v114
    v_add_f32 v19, v19, v115
    v_add_f32 v20, v20, v116
    v_add_f32 v21, v21, v117
    v_add_f32 v22, v22, v118
    v_add_f32 v23, v23, v119
    v_add_f32 v8, v8, v24
    v_add_f32 v9, v9, v25
    v_add_f32 v10, v10, v26
    v_add_f32 v11, v11, v27
    v_add_f32 v12, v12, v28
    v_add_f32 v13, v13, v29
    v_add_f32 v14, v14, v30
    v_add_f32 v15, v15, v31
    v_add_f32 v16, v16, v120
    v_add_f32 v17, v17, v121
    v_add_f32 v18, v18, v122
    v_add_f32 v19, v19, v123
    v_add_f32 v20, v20, v124
    v_add_f32 v21, v21, v125
    v_add_f32 v22, v22, v126
    v_add_f32 v23, v23, v127
    v_cvt_pk_bf16_f32 v96, v8, v9
    v_cvt_pk_bf16_f32 v97, v10, v11
    v_cvt_pk_bf16_f32 v98, v12, v13
    v_cvt_pk_bf16_f32 v99, v14, v15
    v_cvt_pk_bf16_f32 v100, v16, v17
    v_cvt_pk_bf16_f32 v101, v18, v19
    v_cvt_pk_bf16_f32 v102, v20, v21
    v_cvt_pk_bf16_f32 v103, v22, v23
    v_mov_b32 v8, 0
    v_mov_b32 v16, 0
    v_mov_b32 v9, 0
    v_mov_b32 v17, 0
    v_mov_b32 v10, 0
    v_mov_b32 v18, 0
    v_mov_b32 v11, 0
    v_mov_b32 v19, 0
    v_mov_b32 v12, 0
    v_mov_b32 v20, 0
    v_mov_b32 v13, 0
    v_mov_b32 v21, 0
    v_mov_b32 v14, 0
    v_mov_b32 v22, 0
    v_mov_b32 v15, 0
    v_mov_b32 v23, 0
    v_mov_b32 v24, 0xff800000
    v_mov_b32 v25, 0xff800000
    v_mov_b32 v26, 0
    v_mov_b32 v27, 0
    s_mov_b32 s23, 0
La_loop:
    s_waitcnt vmcnt(20)
    v_dot2_f32_bf16 v104, v32, v96, 0
    v_dot2_f32_bf16 v104, v33, v97, v104
    v_dot2_f32_bf16 v104, v34, v98, v104
    v_dot2_f32_bf16 v104, v35, v99, v104
    v_dot2_f32_bf16 v105, v32, v100, 0
    v_dot2_f32_bf16 v105, v33, v101, v105
    v_dot2_f32_bf16 v105, v34, v102, v105
    v_dot2_f32_bf16 v105, v35, v103, v105
    v_dot2_f32_bf16 v106, v36, v96, 0
    v_dot2_f32_bf16 v106, v37, v97, v106
    v_dot2_f32_bf16 v106, v38, v98, v106
    v_dot2_f32_bf16 v106, v39, v99, v106
    v_dot2_f32_bf16 v107, v36, v100, 0
    v_dot2_f32_bf16 v107, v37, v101, v107
    v_dot2_f32_bf16 v107, v38, v102, v107
    v_dot2_f32_bf16 v107, v39, v103, v107
    v_dot2_f32_bf16 v108, v40, v96, 0
    v_dot2_f32_bf16 v108, v41, v97, v108
    v_dot2_f32_bf16 v108, v42, v98, v108
    v_dot2_f32_bf16 v108, v43, v99, v108
    v_dot2_f32_bf16 v109, v40, v100, 0
    v_dot2_f32_bf16 v109, v41, v101, v109
    v_dot2_f32_bf16 v109, v42, v102, v109
    v_dot2_f32_bf16 v109, v43, v103, v109
    v_dot2_f32_bf16 v110, v44, v96, 0
    v_dot2_f32_bf16 v110, v45, v97, v110
    v_dot2_f32_bf16 v110, v46, v98, v110
    v_dot2_f32_bf16 v110, v47, v99, v110
    v_dot2_f32_bf16 v111, v44, v100, 0
    v_dot2_f32_bf16 v111, v45, v101, v111
    v_dot2_f32_bf16 v111, v46, v102, v111
    v_dot2_f32_bf16 v111, v47, v103, v111
    v_add_f32_dpp v104, v104, v104 quad_perm:[1,0,3,2] row_mask:0xf bank_mask:0xf
    v_add_f32_dpp v105, v105, v105 quad_perm:[1,0,3,2] row_mask:0xf bank_mask:0xf
    v_add_f32_dpp v106, v106, v106 quad_perm:[1,0,3,2] row_mask:0xf bank_mask:0xf
    v_add_f32_dpp v107, v107, v107 quad_perm:[1,0,3,2] row_mask:0xf bank_mask:0xf
    v_add_f32_dpp v108, v108, v108 quad_perm:[1,0,3,2] row_mask:0xf bank_mask:0xf
    v_add_f32_dpp v109, v109, v109 quad_perm:[1,0,3,2] row_mask:0xf bank_mask:0xf
    v_add_f32_dpp v110, v110, v110 quad_perm:[1,0,3,2] row_mask:0xf bank_mask:0xf
    v_add_f32_dpp v111, v111, v111 quad_perm:[1,0,3,2] row_mask:0xf bank_mask:0xf
    v_add_f32_dpp v104, v104, v104 quad_perm:[2,3,0,1] row_mask:0xf bank_mask:0xf
    v_add_f32_dpp v105, v105, v105 quad_perm:[2,3,0,1] row_mask:0xf bank_mask:0xf
    v_add_f32_dpp v106, v106, v106 quad_perm:[2,3,0,1] row_mask:0xf bank_mask:0xf
    v_add_f32_dpp v107, v107, v107 quad_perm:[2,3,0,1] row_mask:0xf bank_mask:0xf
    v_add_f32_dpp v108, v108, v108 quad_perm:[2,3,0,1] row_mask:0xf bank_mask:0xf
    v_add_f32_dpp v109, v109, v109 quad_perm:[2,3,0,1] row_mask:0xf bank_mask:0xf
    v_add_f32_dpp v110, v110, v110 quad_perm:[2,3,0,1] row_mask:0xf bank_mask:0xf
    v_add_f32_dpp v111, v111, v111 quad_perm:[2,3,0,1] row_mask:0xf bank_mask:0xf
    v_add_f32_dpp v104, v104, v104 row_ror:4 row_mask:0xf bank_mask:0xf
    v_add_f32_dpp v105, v105, v105 row_ror:4 row_mask:0xf bank_mask:0xf
    v_add_f32_dpp v106, v106, v106 row_ror:4 row_mask:0xf bank_mask:0xf
    v_add_f32_dpp v107, v107, v107 row_ror:4 row_mask:0xf bank_mask:0xf
    v_add_f32_dpp v108, v108, v108 row_ror:4 row_mask:0xf bank_mask:0xf
    v_add_f32_dpp v109, v109, v109 row_ror:4 row_mask:0xf bank_mask:0xf
    v_add_f32_dpp v110, v110, v110 row_ror:4 row_mask:0xf bank_mask:0xf
    v_add_f32_dpp v111, v111, v111 row_ror:4 row_mask:0xf bank_mask:0xf
    v_add_f32_dpp v104, v104, v104 row_ror:8 row_mask:0xf bank_mask:0xf
    v_add_f32_dpp v105, v105, v105 row_ror:8 row_mask:0xf bank_mask:0xf
    v_add_f32_dpp v106, v106, v106 row_ror:8 row_mask:0xf bank_mask:0xf
    v_add_f32_dpp v107, v107, v107 row_ror:8 row_mask:0xf bank_mask:0xf
    v_add_f32_dpp v108, v108, v108 row_ror:8 row_mask:0xf bank_mask:0xf
    v_add_f32_dpp v109, v109, v109 row_ror:8 row_mask:0xf bank_mask:0xf
    v_add_f32_dpp v110, v110, v110 row_ror:8 row_mask:0xf bank_mask:0xf
    v_add_f32_dpp v111, v111, v111 row_ror:8 row_mask:0xf bank_mask:0xf
    v_max3_f32 v28, v104, v106, v108
    v_max3_f32 v28, v28, v110, v24
    v_sub_f32 v30, v24, v28
    v_mul_f32 v30, s20, v30
    v_mul_f32 v120, s20, v28
    v_exp_f32 v30, v30
    v_mov_b32 v24, v28
    v_fma_f32 v104, v104, s20, -v120
    v_fma_f32 v106, v106, s20, -v120
    v_fma_f32 v108, v108, s20, -v120
    v_fma_f32 v110, v110, s20, -v120
    v_exp_f32 v104, v104
    v_exp_f32 v106, v106
    v_exp_f32 v108, v108
    v_exp_f32 v110, v110
    v_mul_f32 v26, v26, v30
    v_mul_f32 v8, v8, v30
    v_mul_f32 v9, v9, v30
    v_mul_f32 v10, v10, v30
    v_mul_f32 v11, v11, v30
    v_mul_f32 v12, v12, v30
    v_mul_f32 v13, v13, v30
    v_mul_f32 v14, v14, v30
    v_mul_f32 v15, v15, v30
    v_add_f32 v28, v104, v106
    v_add_f32 v26, v26, v28
    v_add_f32 v28, v108, v110
    v_add_f32 v26, v26, v28
    v_max3_f32 v29, v105, v107, v109
    v_max3_f32 v29, v29, v111, v25
    v_sub_f32 v31, v25, v29
    v_mul_f32 v31, s20, v31
    v_mul_f32 v121, s20, v29
    v_exp_f32 v31, v31
    v_mov_b32 v25, v29
    v_fma_f32 v105, v105, s20, -v121
    v_fma_f32 v107, v107, s20, -v121
    v_fma_f32 v109, v109, s20, -v121
    v_fma_f32 v111, v111, s20, -v121
    v_exp_f32 v105, v105
    v_exp_f32 v107, v107
    v_exp_f32 v109, v109
    v_exp_f32 v111, v111
    v_mul_f32 v27, v27, v31
    v_mul_f32 v16, v16, v31
    v_mul_f32 v17, v17, v31
    v_mul_f32 v18, v18, v31
    v_mul_f32 v19, v19, v31
    v_mul_f32 v20, v20, v31
    v_mul_f32 v21, v21, v31
    v_mul_f32 v22, v22, v31
    v_mul_f32 v23, v23, v31
    v_add_f32 v29, v105, v107
    v_add_f32 v27, v27, v29
    v_add_f32 v29, v109, v111
    v_add_f32 v27, v27, v29
    s_waitcnt vmcnt(16)
    v_lshlrev_b32 v112, 16, v48
    v_and_b32 v113, 0xffff0000, v48
    v_lshlrev_b32 v114, 16, v49
    v_and_b32 v115, 0xffff0000, v49
    v_lshlrev_b32 v116, 16, v50
    v_and_b32 v117, 0xffff0000, v50
    v_lshlrev_b32 v118, 16, v51
    v_and_b32 v119, 0xffff0000, v51
    v_fmac_f32 v8, v104, v112
    v_fmac_f32 v16, v105, v112
    v_fmac_f32 v9, v104, v113
    v_fmac_f32 v17, v105, v113
    v_fmac_f32 v10, v104, v114
    v_fmac_f32 v18, v105, v114
    v_fmac_f32 v11, v104, v115
    v_fmac_f32 v19, v105, v115
    v_fmac_f32 v12, v104, v116
    v_fmac_f32 v20, v105, v116
    v_fmac_f32 v13, v104, v117
    v_fmac_f32 v21, v105, v117
    v_fmac_f32 v14, v104, v118
    v_fmac_f32 v22, v105, v118
    v_fmac_f32 v15, v104, v119
    v_fmac_f32 v23, v105, v119
    v_lshlrev_b32 v112, 16, v52
    v_and_b32 v113, 0xffff0000, v52
    v_lshlrev_b32 v114, 16, v53
    v_and_b32 v115, 0xffff0000, v53
    v_lshlrev_b32 v116, 16, v54
    v_and_b32 v117, 0xffff0000, v54
    v_lshlrev_b32 v118, 16, v55
    v_and_b32 v119, 0xffff0000, v55
    v_fmac_f32 v8, v106, v112
    v_fmac_f32 v16, v107, v112
    v_fmac_f32 v9, v106, v113
    v_fmac_f32 v17, v107, v113
    v_fmac_f32 v10, v106, v114
    v_fmac_f32 v18, v107, v114
    v_fmac_f32 v11, v106, v115
    v_fmac_f32 v19, v107, v115
    v_fmac_f32 v12, v106, v116
    v_fmac_f32 v20, v107, v116
    v_fmac_f32 v13, v106, v117
    v_fmac_f32 v21, v107, v117
    v_fmac_f32 v14, v106, v118
    v_fmac_f32 v22, v107, v118
    v_fmac_f32 v15, v106, v119
    v_fmac_f32 v23, v107, v119
    v_lshlrev_b32 v112, 16, v56
    v_and_b32 v113, 0xffff0000, v56
    v_lshlrev_b32 v114, 16, v57
    v_and_b32 v115, 0xffff0000, v57
    v_lshlrev_b32 v116, 16, v58
    v_and_b32 v117, 0xffff0000, v58
    v_lshlrev_b32 v118, 16, v59
    v_and_b32 v119, 0xffff0000, v59
    v_fmac_f32 v8, v108, v112
    v_fmac_f32 v16, v109, v112
    v_fmac_f32 v9, v108, v113
    v_fmac_f32 v17, v109, v113
    v_fmac_f32 v10, v108, v114
    v_fmac_f32 v18, v109, v114
    v_fmac_f32 v11, v108, v115
    v_fmac_f32 v19, v109, v115
    v_fmac_f32 v12, v108, v116
    v_fmac_f32 v20, v109, v116
    v_fmac_f32 v13, v108, v117
    v_fmac_f32 v21, v109, v117
    v_fmac_f32 v14, v108, v118
    v_fmac_f32 v22, v109, v118
    v_fmac_f32 v15, v108, v119
    v_fmac_f32 v23, v109, v119
    v_lshlrev_b32 v112, 16, v60
    v_and_b32 v113, 0xffff0000, v60
    v_lshlrev_b32 v114, 16, v61
    v_and_b32 v115, 0xffff0000, v61
    v_lshlrev_b32 v116, 16, v62
    v_and_b32 v117, 0xffff0000, v62
    v_lshlrev_b32 v118, 16, v63
    v_and_b32 v119, 0xffff0000, v63
    v_fmac_f32 v8, v110, v112
    v_fmac_f32 v16, v111, v112
    v_fmac_f32 v9, v110, v113
    v_fmac_f32 v17, v111, v113
    v_fmac_f32 v10, v110, v114
    v_fmac_f32 v18, v111, v114
    v_fmac_f32 v11, v110, v115
    v_fmac_f32 v19, v111, v115
    v_fmac_f32 v12, v110, v116
    v_fmac_f32 v20, v111, v116
    v_fmac_f32 v13, v110, v117
    v_fmac_f32 v21, v111, v117
    v_fmac_f32 v14, v110, v118
    v_fmac_f32 v22, v111, v118
    v_fmac_f32 v15, v110, v119
    v_fmac_f32 v23, v111, v119
    global_load_dwordx4 v[32:35], v2, s[4:5] offset:0 nt
    global_load_dwordx4 v[36:39], v2, s[4:5] offset:1024 nt
    global_load_dwordx4 v[40:43], v2, s[4:5] offset:2048 nt
    global_load_dwordx4 v[44:47], v2, s[4:5] offset:3072 nt
    global_load_dwordx4 v[48:51], v2, s[6:7] offset:0 nt
    global_load_dwordx4 v[52:55], v2, s[6:7] offset:1024 nt
    global_load_dwordx4 v[56:59], v2, s[6:7] offset:2048 nt
    global_load_dwordx4 v[60:63], v2, s[6:7] offset:3072 nt
    s_add_u32 s4, s4, 32768
    s_addc_u32 s5, s5, 0
    s_add_u32 s6, s6, 32768
    s_addc_u32 s7, s7, 0
    s_waitcnt vmcnt(20)
    v_dot2_f32_bf16 v104, v64, v96, 0
    v_dot2_f32_bf16 v104, v65, v97, v104
    v_dot2_f32_bf16 v104, v66, v98, v104
    v_dot2_f32_bf16 v104, v67, v99, v104
    v_dot2_f32_bf16 v105, v64, v100, 0
    v_dot2_f32_bf16 v105, v65, v101, v105
    v_dot2_f32_bf16 v105, v66, v102, v105
    v_dot2_f32_bf16 v105, v67, v103, v105
    v_dot2_f32_bf16 v106, v68, v96, 0
    v_dot2_f32_bf16 v106, v69, v97, v106
    v_dot2_f32_bf16 v106, v70, v98, v106
    v_dot2_f32_bf16 v106, v71, v99, v106
    v_dot2_f32_bf16 v107, v68, v100, 0
    v_dot2_f32_bf16 v107, v69, v101, v107
    v_dot2_f32_bf16 v107, v70, v102, v107
    v_dot2_f32_bf16 v107, v71, v103, v107
    v_dot2_f32_bf16 v108, v72, v96, 0
    v_dot2_f32_bf16 v108, v73, v97, v108
    v_dot2_f32_bf16 v108, v74, v98, v108
    v_dot2_f32_bf16 v108, v75, v99, v108
    v_dot2_f32_bf16 v109, v72, v100, 0
    v_dot2_f32_bf16 v109, v73, v101, v109
    v_dot2_f32_bf16 v109, v74, v102, v109
    v_dot2_f32_bf16 v109, v75, v103, v109
    v_dot2_f32_bf16 v110, v76, v96, 0
    v_dot2_f32_bf16 v110, v77, v97, v110
    v_dot2_f32_bf16 v110, v78, v98, v110
    v_dot2_f32_bf16 v110, v79, v99, v110
    v_dot2_f32_bf16 v111, v76, v100, 0
    v_dot2_f32_bf16 v111, v77, v101, v111
    v_dot2_f32_bf16 v111, v78, v102, v111
    v_dot2_f32_bf16 v111, v79, v103, v111
    v_add_f32_dpp v104, v104, v104 quad_perm:[1,0,3,2] row_mask:0xf bank_mask:0xf
    v_add_f32_dpp v105, v105, v105 quad_perm:[1,0,3,2] row_mask:0xf bank_mask:0xf
    v_add_f32_dpp v106, v106, v106 quad_perm:[1,0,3,2] row_mask:0xf bank_mask:0xf
    v_add_f32_dpp v107, v107, v107 quad_perm:[1,0,3,2] row_mask:0xf bank_mask:0xf
    v_add_f32_dpp v108, v108, v108 quad_perm:[1,0,3,2] row_mask:0xf bank_mask:0xf
    v_add_f32_dpp v109, v109, v109 quad_perm:[1,0,3,2] row_mask:0xf bank_mask:0xf
    v_add_f32_dpp v110, v110, v110 quad_perm:[1,0,3,2] row_mask:0xf bank_mask:0xf
    v_add_f32_dpp v111, v111, v111 quad_perm:[1,0,3,2] row_mask:0xf bank_mask:0xf
    v_add_f32_dpp v104, v104, v104 quad_perm:[2,3,0,1] row_mask:0xf bank_mask:0xf
    v_add_f32_dpp v105, v105, v105 quad_perm:[2,3,0,1] row_mask:0xf bank_mask:0xf
    v_add_f32_dpp v106, v106, v106 quad_perm:[2,3,0,1] row_mask:0xf bank_mask:0xf
    v_add_f32_dpp v107, v107, v107 quad_perm:[2,3,0,1] row_mask:0xf bank_mask:0xf
    v_add_f32_dpp v108, v108, v108 quad_perm:[2,3,0,1] row_mask:0xf bank_mask:0xf
    v_add_f32_dpp v109, v109, v109 quad_perm:[2,3,0,1] row_mask:0xf bank_mask:0xf
    v_add_f32_dpp v110, v110, v110 quad_perm:[2,3,0,1] row_mask:0xf bank_mask:0xf
    v_add_f32_dpp v111, v111, v111 quad_perm:[2,3,0,1] row_mask:0xf bank_mask:0xf
    v_add_f32_dpp v104, v104, v104 row_ror:4 row_mask:0xf bank_mask:0xf
    v_add_f32_dpp v105, v105, v105 row_ror:4 row_mask:0xf bank_mask:0xf
    v_add_f32_dpp v106, v106, v106 row_ror:4 row_mask:0xf bank_mask:0xf
    v_add_f32_dpp v107, v107, v107 row_ror:4 row_mask:0xf bank_mask:0xf
    v_add_f32_dpp v108, v108, v108 row_ror:4 row_mask:0xf bank_mask:0xf
    v_add_f32_dpp v109, v109, v109 row_ror:4 row_mask:0xf bank_mask:0xf
    v_add_f32_dpp v110, v110, v110 row_ror:4 row_mask:0xf bank_mask:0xf
    v_add_f32_dpp v111, v111, v111 row_ror:4 row_mask:0xf bank_mask:0xf
    v_add_f32_dpp v104, v104, v104 row_ror:8 row_mask:0xf bank_mask:0xf
    v_add_f32_dpp v105, v105, v105 row_ror:8 row_mask:0xf bank_mask:0xf
    v_add_f32_dpp v106, v106, v106 row_ror:8 row_mask:0xf bank_mask:0xf
    v_add_f32_dpp v107, v107, v107 row_ror:8 row_mask:0xf bank_mask:0xf
    v_add_f32_dpp v108, v108, v108 row_ror:8 row_mask:0xf bank_mask:0xf
    v_add_f32_dpp v109, v109, v109 row_ror:8 row_mask:0xf bank_mask:0xf
    v_add_f32_dpp v110, v110, v110 row_ror:8 row_mask:0xf bank_mask:0xf
    v_add_f32_dpp v111, v111, v111 row_ror:8 row_mask:0xf bank_mask:0xf
    v_max3_f32 v28, v104, v106, v108
    v_max3_f32 v28, v28, v110, v24
    v_sub_f32 v30, v24, v28
    v_mul_f32 v30, s20, v30
    v_mul_f32 v120, s20, v28
    v_exp_f32 v30, v30
    v_mov_b32 v24, v28
    v_fma_f32 v104, v104, s20, -v120
    v_fma_f32 v106, v106, s20, -v120
    v_fma_f32 v108, v108, s20, -v120
    v_fma_f32 v110, v110, s20, -v120
    v_exp_f32 v104, v104
    v_exp_f32 v106, v106
    v_exp_f32 v108, v108
    v_exp_f32 v110, v110
    v_mul_f32 v26, v26, v30
    v_mul_f32 v8, v8, v30
    v_mul_f32 v9, v9, v30
    v_mul_f32 v10, v10, v30
    v_mul_f32 v11, v11, v30
    v_mul_f32 v12, v12, v30
    v_mul_f32 v13, v13, v30
    v_mul_f32 v14, v14, v30
    v_mul_f32 v15, v15, v30
    v_add_f32 v28, v104, v106
    v_add_f32 v26, v26, v28
    v_add_f32 v28, v108, v110
    v_add_f32 v26, v26, v28
    v_max3_f32 v29, v105, v107, v109
    v_max3_f32 v29, v29, v111, v25
    v_sub_f32 v31, v25, v29
    v_mul_f32 v31, s20, v31
    v_mul_f32 v121, s20, v29
    v_exp_f32 v31, v31
    v_mov_b32 v25, v29
    v_fma_f32 v105, v105, s20, -v121
    v_fma_f32 v107, v107, s20, -v121
    v_fma_f32 v109, v109, s20, -v121
    v_fma_f32 v111, v111, s20, -v121
    v_exp_f32 v105, v105
    v_exp_f32 v107, v107
    v_exp_f32 v109, v109
    v_exp_f32 v111, v111
    v_mul_f32 v27, v27, v31
    v_mul_f32 v16, v16, v31
    v_mul_f32 v17, v17, v31
    v_mul_f32 v18, v18, v31
    v_mul_f32 v19, v19, v31
    v_mul_f32 v20, v20, v31
    v_mul_f32 v21, v21, v31
    v_mul_f32 v22, v22, v31
    v_mul_f32 v23, v23, v31
    v_add_f32 v29, v105, v107
    v_add_f32 v27, v27, v29
    v_add_f32 v29, v109, v111
    v_add_f32 v27, v27, v29
    s_waitcnt vmcnt(16)
    v_lshlrev_b32 v112, 16, v80
    v_and_b32 v113, 0xffff0000, v80
    v_lshlrev_b32 v114, 16, v81
    v_and_b32 v115, 0xffff0000, v81
    v_lshlrev_b32 v116, 16, v82
    v_and_b32 v117, 0xffff0000, v82
    v_lshlrev_b32 v118, 16, v83
    v_and_b32 v119, 0xffff0000, v83
    v_fmac_f32 v8, v104, v112
    v_fmac_f32 v16, v105, v112
    v_fmac_f32 v9, v104, v113
    v_fmac_f32 v17, v105, v113
    v_fmac_f32 v10, v104, v114
    v_fmac_f32 v18, v105, v114
    v_fmac_f32 v11, v104, v115
    v_fmac_f32 v19, v105, v115
    v_fmac_f32 v12, v104, v116
    v_fmac_f32 v20, v105, v116
    v_fmac_f32 v13, v104, v117
    v_fmac_f32 v21, v105, v117
    v_fmac_f32 v14, v104, v118
    v_fmac_f32 v22, v105, v118
    v_fmac_f32 v15, v104, v119
    v_fmac_f32 v23, v105, v119
    v_lshlrev_b32 v112, 16, v84
    v_and_b32 v113, 0xffff0000, v84
    v_lshlrev_b32 v114, 16, v85
    v_and_b32 v115, 0xffff0000, v85
    v_lshlrev_b32 v116, 16, v86
    v_and_b32 v117, 0xffff0000, v86
    v_lshlrev_b32 v118, 16, v87
    v_and_b32 v119, 0xffff0000, v87
    v_fmac_f32 v8, v106, v112
    v_fmac_f32 v16, v107, v112
    v_fmac_f32 v9, v106, v113
    v_fmac_f32 v17, v107, v113
    v_fmac_f32 v10, v106, v114
    v_fmac_f32 v18, v107, v114
    v_fmac_f32 v11, v106, v115
    v_fmac_f32 v19, v107, v115
    v_fmac_f32 v12, v106, v116
    v_fmac_f32 v20, v107, v116
    v_fmac_f32 v13, v106, v117
    v_fmac_f32 v21, v107, v117
    v_fmac_f32 v14, v106, v118
    v_fmac_f32 v22, v107, v118
    v_fmac_f32 v15, v106, v119
    v_fmac_f32 v23, v107, v119
    v_lshlrev_b32 v112, 16, v88
    v_and_b32 v113, 0xffff0000, v88
    v_lshlrev_b32 v114, 16, v89
    v_and_b32 v115, 0xffff0000, v89
    v_lshlrev_b32 v116, 16, v90
    v_and_b32 v117, 0xffff0000, v90
    v_lshlrev_b32 v118, 16, v91
    v_and_b32 v119, 0xffff0000, v91
    v_fmac_f32 v8, v108, v112
    v_fmac_f32 v16, v109, v112
    v_fmac_f32 v9, v108, v113
    v_fmac_f32 v17, v109, v113
    v_fmac_f32 v10, v108, v114
    v_fmac_f32 v18, v109, v114
    v_fmac_f32 v11, v108, v115
    v_fmac_f32 v19, v109, v115
    v_fmac_f32 v12, v108, v116
    v_fmac_f32 v20, v109, v116
    v_fmac_f32 v13, v108, v117
    v_fmac_f32 v21, v109, v117
    v_fmac_f32 v14, v108, v118
    v_fmac_f32 v22, v109, v118
    v_fmac_f32 v15, v108, v119
    v_fmac_f32 v23, v109, v119
    v_lshlrev_b32 v112, 16, v92
    v_and_b32 v113, 0xffff0000, v92
    v_lshlrev_b32 v114, 16, v93
    v_and_b32 v115, 0xffff0000, v93
    v_lshlrev_b32 v116, 16, v94
    v_and_b32 v117, 0xffff0000, v94
    v_lshlrev_b32 v118, 16, v95
    v_and_b32 v119, 0xffff0000, v95
    v_fmac_f32 v8, v110, v112
    v_fmac_f32 v16, v111, v112
    v_fmac_f32 v9, v110, v113
    v_fmac_f32 v17, v111, v113
    v_fmac_f32 v10, v110, v114
    v_fmac_f32 v18, v111, v114
    v_fmac_f32 v11, v110, v115
    v_fmac_f32 v19, v111, v115
    v_fmac_f32 v12, v110, v116
    v_fmac_f32 v20, v111, v116
    v_fmac_f32 v13, v110, v117
    v_fmac_f32 v21, v111, v117
    v_fmac_f32 v14, v110, v118
    v_fmac_f32 v22, v111, v118
    v_fmac_f32 v15, v110, v119
    v_fmac_f32 v23, v111, v119
    global_load_dwordx4 v[64:67], v2, s[4:5] offset:0 nt
    global_load_dwordx4 v[68:71], v2, s[4:5] offset:1024 nt
    global_load_dwordx4 v[72:75], v2, s[4:5] offset:2048 nt
    global_load_dwordx4 v[76:79], v2, s[4:5] offset:3072 nt
    global_load_dwordx4 v[80:83], v2, s[6:7] offset:0 nt
    global_load_dwordx4 v[84:87], v2, s[6:7] offset:1024 nt
    global_load_dwordx4 v[88:91], v2, s[6:7] offset:2048 nt
    global_load_dwordx4 v[92:95], v2, s[6:7] offset:3072 nt
    s_add_u32 s4, s4, 32768
    s_addc_u32 s5, s5, 0
    s_add_u32 s6, s6, 32768
    s_addc_u32 s7, s7, 0
    s_waitcnt vmcnt(20)
    v_dot2_f32_bf16 v104, v128, v96, 0
    v_dot2_f32_bf16 v104, v129, v97, v104
    v_dot2_f32_bf16 v104, v130, v98, v104
    v_dot2_f32_bf16 v104, v131, v99, v104
    v_dot2_f32_bf16 v105, v128, v100, 0
    v_dot2_f32_bf16 v105, v129, v101, v105
    v_dot2_f32_bf16 v105, v130, v102, v105
    v_dot2_f32_bf16 v105, v131, v103, v105
    v_dot2_f32_bf16 v106, v132, v96, 0
    v_dot2_f32_bf16 v106, v133, v97, v106
    v_dot2_f32_bf16 v106, v134, v98, v106
    v_dot2_f32_bf16 v106, v135, v99, v106
    v_dot2_f32_bf16 v107, v132, v100, 0
    v_dot2_f32_bf16 v107, v133, v101, v107
    v_dot2_f32_bf16 v107, v134, v102, v107
    v_dot2_f32_bf16 v107, v135, v103, v107
    v_dot2_f32_bf16 v108, v136, v96, 0
    v_dot2_f32_bf16 v108, v137, v97, v108
    v_dot2_f32_bf16 v108, v138, v98, v108
    v_dot2_f32_bf16 v108, v139, v99, v108
    v_dot2_f32_bf16 v109, v136, v100, 0
    v_dot2_f32_bf16 v109, v137, v101, v109
    v_dot2_f32_bf16 v109, v138, v102, v109
    v_dot2_f32_bf16 v109, v139, v103, v109
    v_dot2_f32_bf16 v110, v140, v96, 0
    v_dot2_f32_bf16 v110, v141, v97, v110
    v_dot2_f32_bf16 v110, v142, v98, v110
    v_dot2_f32_bf16 v110, v143, v99, v110
    v_dot2_f32_bf16 v111, v140, v100, 0
    v_dot2_f32_bf16 v111, v141, v101, v111
    v_dot2_f32_bf16 v111, v142, v102, v111
    v_dot2_f32_bf16 v111, v143, v103, v111
    v_add_f32_dpp v104, v104, v104 quad_perm:[1,0,3,2] row_mask:0xf bank_mask:0xf
    v_add_f32_dpp v105, v105, v105 quad_perm:[1,0,3,2] row_mask:0xf bank_mask:0xf
    v_add_f32_dpp v106, v106, v106 quad_perm:[1,0,3,2] row_mask:0xf bank_mask:0xf
    v_add_f32_dpp v107, v107, v107 quad_perm:[1,0,3,2] row_mask:0xf bank_mask:0xf
    v_add_f32_dpp v108, v108, v108 quad_perm:[1,0,3,2] row_mask:0xf bank_mask:0xf
    v_add_f32_dpp v109, v109, v109 quad_perm:[1,0,3,2] row_mask:0xf bank_mask:0xf
    v_add_f32_dpp v110, v110, v110 quad_perm:[1,0,3,2] row_mask:0xf bank_mask:0xf
    v_add_f32_dpp v111, v111, v111 quad_perm:[1,0,3,2] row_mask:0xf bank_mask:0xf
    v_add_f32_dpp v104, v104, v104 quad_perm:[2,3,0,1] row_mask:0xf bank_mask:0xf
    v_add_f32_dpp v105, v105, v105 quad_perm:[2,3,0,1] row_mask:0xf bank_mask:0xf
    v_add_f32_dpp v106, v106, v106 quad_perm:[2,3,0,1] row_mask:0xf bank_mask:0xf
    v_add_f32_dpp v107, v107, v107 quad_perm:[2,3,0,1] row_mask:0xf bank_mask:0xf
    v_add_f32_dpp v108, v108, v108 quad_perm:[2,3,0,1] row_mask:0xf bank_mask:0xf
    v_add_f32_dpp v109, v109, v109 quad_perm:[2,3,0,1] row_mask:0xf bank_mask:0xf
    v_add_f32_dpp v110, v110, v110 quad_perm:[2,3,0,1] row_mask:0xf bank_mask:0xf
    v_add_f32_dpp v111, v111, v111 quad_perm:[2,3,0,1] row_mask:0xf bank_mask:0xf
    v_add_f32_dpp v104, v104, v104 row_ror:4 row_mask:0xf bank_mask:0xf
    v_add_f32_dpp v105, v105, v105 row_ror:4 row_mask:0xf bank_mask:0xf
    v_add_f32_dpp v106, v106, v106 row_ror:4 row_mask:0xf bank_mask:0xf
    v_add_f32_dpp v107, v107, v107 row_ror:4 row_mask:0xf bank_mask:0xf
    v_add_f32_dpp v108, v108, v108 row_ror:4 row_mask:0xf bank_mask:0xf
    v_add_f32_dpp v109, v109, v109 row_ror:4 row_mask:0xf bank_mask:0xf
    v_add_f32_dpp v110, v110, v110 row_ror:4 row_mask:0xf bank_mask:0xf
    v_add_f32_dpp v111, v111, v111 row_ror:4 row_mask:0xf bank_mask:0xf
    v_add_f32_dpp v104, v104, v104 row_ror:8 row_mask:0xf bank_mask:0xf
    v_add_f32_dpp v105, v105, v105 row_ror:8 row_mask:0xf bank_mask:0xf
    v_add_f32_dpp v106, v106, v106 row_ror:8 row_mask:0xf bank_mask:0xf
    v_add_f32_dpp v107, v107, v107 row_ror:8 row_mask:0xf bank_mask:0xf
    v_add_f32_dpp v108, v108, v108 row_ror:8 row_mask:0xf bank_mask:0xf
    v_add_f32_dpp v109, v109, v109 row_ror:8 row_mask:0xf bank_mask:0xf
    v_add_f32_dpp v110, v110, v110 row_ror:8 row_mask:0xf bank_mask:0xf
    v_add_f32_dpp v111, v111, v111 row_ror:8 row_mask:0xf bank_mask:0xf
    v_max3_f32 v28, v104, v106, v108
    v_max3_f32 v28, v28, v110, v24
    v_sub_f32 v30, v24, v28
    v_mul_f32 v30, s20, v30
    v_mul_f32 v120, s20, v28
    v_exp_f32 v30, v30
    v_mov_b32 v24, v28
    v_fma_f32 v104, v104, s20, -v120
    v_fma_f32 v106, v106, s20, -v120
    v_fma_f32 v108, v108, s20, -v120
    v_fma_f32 v110, v110, s20, -v120
    v_exp_f32 v104, v104
    v_exp_f32 v106, v106
    v_exp_f32 v108, v108
    v_exp_f32 v110, v110
    v_mul_f32 v26, v26, v30
    v_mul_f32 v8, v8, v30
    v_mul_f32 v9, v9, v30
    v_mul_f32 v10, v10, v30
    v_mul_f32 v11, v11, v30
    v_mul_f32 v12, v12, v30
    v_mul_f32 v13, v13, v30
    v_mul_f32 v14, v14, v30
    v_mul_f32 v15, v15, v30
    v_add_f32 v28, v104, v106
    v_add_f32 v26, v26, v28
    v_add_f32 v28, v108, v110
    v_add_f32 v26, v26, v28
    v_max3_f32 v29, v105, v107, v109
    v_max3_f32 v29, v29, v111, v25
    v_sub_f32 v31, v25, v29
    v_mul_f32 v31, s20, v31
    v_mul_f32 v121, s20, v29
    v_exp_f32 v31, v31
    v_mov_b32 v25, v29
    v_fma_f32 v105, v105, s20, -v121
    v_fma_f32 v107, v107, s20, -v121
    v_fma_f32 v109, v109, s20, -v121
    v_fma_f32 v111, v111, s20, -v121
    v_exp_f32 v105, v105
    v_exp_f32 v107, v107
    v_exp_f32 v109, v109
    v_exp_f32 v111, v111
    v_mul_f32 v27, v27, v31
    v_mul_f32 v16, v16, v31
    v_mul_f32 v17, v17, v31
    v_mul_f32 v18, v18, v31
    v_mul_f32 v19, v19, v31
    v_mul_f32 v20, v20, v31
    v_mul_f32 v21, v21, v31
    v_mul_f32 v22, v22, v31
    v_mul_f32 v23, v23, v31
    v_add_f32 v29, v105, v107
    v_add_f32 v27, v27, v29
    v_add_f32 v29, v109, v111
    v_add_f32 v27, v27, v29
    s_waitcnt vmcnt(16)
    v_lshlrev_b32 v112, 16, v144
    v_and_b32 v113, 0xffff0000, v144
    v_lshlrev_b32 v114, 16, v145
    v_and_b32 v115, 0xffff0000, v145
    v_lshlrev_b32 v116, 16, v146
    v_and_b32 v117, 0xffff0000, v146
    v_lshlrev_b32 v118, 16, v147
    v_and_b32 v119, 0xffff0000, v147
    v_fmac_f32 v8, v104, v112
    v_fmac_f32 v16, v105, v112
    v_fmac_f32 v9, v104, v113
    v_fmac_f32 v17, v105, v113
    v_fmac_f32 v10, v104, v114
    v_fmac_f32 v18, v105, v114
    v_fmac_f32 v11, v104, v115
    v_fmac_f32 v19, v105, v115
    v_fmac_f32 v12, v104, v116
    v_fmac_f32 v20, v105, v116
    v_fmac_f32 v13, v104, v117
    v_fmac_f32 v21, v105, v117
    v_fmac_f32 v14, v104, v118
    v_fmac_f32 v22, v105, v118
    v_fmac_f32 v15, v104, v119
    v_fmac_f32 v23, v105, v119
    v_lshlrev_b32 v112, 16, v148
    v_and_b32 v113, 0xffff0000, v148
    v_lshlrev_b32 v114, 16, v149
    v_and_b32 v115, 0xffff0000, v149
    v_lshlrev_b32 v116, 16, v150
    v_and_b32 v117, 0xffff0000, v150
    v_lshlrev_b32 v118, 16, v151
    v_and_b32 v119, 0xffff0000, v151
    v_fmac_f32 v8, v106, v112
    v_fmac_f32 v16, v107, v112
    v_fmac_f32 v9, v106, v113
    v_fmac_f32 v17, v107, v113
    v_fmac_f32 v10, v106, v114
    v_fmac_f32 v18, v107, v114
    v_fmac_f32 v11, v106, v115
    v_fmac_f32 v19, v107, v115
    v_fmac_f32 v12, v106, v116
    v_fmac_f32 v20, v107, v116
    v_fmac_f32 v13, v106, v117
    v_fmac_f32 v21, v107, v117
    v_fmac_f32 v14, v106, v118
    v_fmac_f32 v22, v107, v118
    v_fmac_f32 v15, v106, v119
    v_fmac_f32 v23, v107, v119
    v_lshlrev_b32 v112, 16, v152
    v_and_b32 v113, 0xffff0000, v152
    v_lshlrev_b32 v114, 16, v153
    v_and_b32 v115, 0xffff0000, v153
    v_lshlrev_b32 v116, 16, v154
    v_and_b32 v117, 0xffff0000, v154
    v_lshlrev_b32 v118, 16, v155
    v_and_b32 v119, 0xffff0000, v155
    v_fmac_f32 v8, v108, v112
    v_fmac_f32 v16, v109, v112
    v_fmac_f32 v9, v108, v113
    v_fmac_f32 v17, v109, v113
    v_fmac_f32 v10, v108, v114
    v_fmac_f32 v18, v109, v114
    v_fmac_f32 v11, v108, v115
    v_fmac_f32 v19, v109, v115
    v_fmac_f32 v12, v108, v116
    v_fmac_f32 v20, v109, v116
    v_fmac_f32 v13, v108, v117
    v_fmac_f32 v21, v109, v117
    v_fmac_f32 v14, v108, v118
    v_fmac_f32 v22, v109, v118
    v_fmac_f32 v15, v108, v119
    v_fmac_f32 v23, v109, v119
    v_lshlrev_b32 v112, 16, v156
    v_and_b32 v113, 0xffff0000, v156
    v_lshlrev_b32 v114, 16, v157
    v_and_b32 v115, 0xffff0000, v157
    v_lshlrev_b32 v116, 16, v158
    v_and_b32 v117, 0xffff0000, v158
    v_lshlrev_b32 v118, 16, v159
    v_and_b32 v119, 0xffff0000, v159
    v_fmac_f32 v8, v110, v112
    v_fmac_f32 v16, v111, v112
    v_fmac_f32 v9, v110, v113
    v_fmac_f32 v17, v111, v113
    v_fmac_f32 v10, v110, v114
    v_fmac_f32 v18, v111, v114
    v_fmac_f32 v11, v110, v115
    v_fmac_f32 v19, v111, v115
    v_fmac_f32 v12, v110, v116
    v_fmac_f32 v20, v111, v116
    v_fmac_f32 v13, v110, v117
    v_fmac_f32 v21, v111, v117
    v_fmac_f32 v14, v110, v118
    v_fmac_f32 v22, v111, v118
    v_fmac_f32 v15, v110, v119
    v_fmac_f32 v23, v111, v119
    global_load_dwordx4 v[128:131], v2, s[4:5] offset:0 nt
    global_load_dwordx4 v[132:135], v2, s[4:5] offset:1024 nt
    global_load_dwordx4 v[136:139], v2, s[4:5] offset:2048 nt
    global_load_dwordx4 v[140:143], v2, s[4:5] offset:3072 nt
    global_load_dwordx4 v[144:147], v2, s[6:7] offset:0 nt
    global_load_dwordx4 v[148:151], v2, s[6:7] offset:1024 nt
    global_load_dwordx4 v[152:155], v2, s[6:7] offset:2048 nt
    global_load_dwordx4 v[156:159], v2, s[6:7] offset:3072 nt
    s_add_u32 s4, s4, 32768
    s_addc_u32 s5, s5, 0
    s_add_u32 s6, s6, 32768
    s_addc_u32 s7, s7, 0
    s_add_u32 s23, s23, 1
    s_cmp_lt_u32 s23, 9
    s_cbranch_scc1 La_loop
    s_waitcnt vmcnt(20)
    v_dot2_f32_bf16 v104, v32, v96, 0
    v_dot2_f32_bf16 v104, v33, v97, v104
    v_dot2_f32_bf16 v104, v34, v98, v104
    v_dot2_f32_bf16 v104, v35, v99, v104
    v_dot2_f32_bf16 v105, v32, v100, 0
    v_dot2_f32_bf16 v105, v33, v101, v105
    v_dot2_f32_bf16 v105, v34, v102, v105
    v_dot2_f32_bf16 v105, v35, v103, v105
    v_dot2_f32_bf16 v106, v36, v96, 0
    v_dot2_f32_bf16 v106, v37, v97, v106
    v_dot2_f32_bf16 v106, v38, v98, v106
    v_dot2_f32_bf16 v106, v39, v99, v106
    v_dot2_f32_bf16 v107, v36, v100, 0
    v_dot2_f32_bf16 v107, v37, v101, v107
    v_dot2_f32_bf16 v107, v38, v102, v107
    v_dot2_f32_bf16 v107, v39, v103, v107
    v_dot2_f32_bf16 v108, v40, v96, 0
    v_dot2_f32_bf16 v108, v41, v97, v108
    v_dot2_f32_bf16 v108, v42, v98, v108
    v_dot2_f32_bf16 v108, v43, v99, v108
    v_dot2_f32_bf16 v109, v40, v100, 0
    v_dot2_f32_bf16 v109, v41, v101, v109
    v_dot2_f32_bf16 v109, v42, v102, v109
    v_dot2_f32_bf16 v109, v43, v103, v109
    v_dot2_f32_bf16 v110, v44, v96, 0
    v_dot2_f32_bf16 v110, v45, v97, v110
    v_dot2_f32_bf16 v110, v46, v98, v110
    v_dot2_f32_bf16 v110, v47, v99, v110
    v_dot2_f32_bf16 v111, v44, v100, 0
    v_dot2_f32_bf16 v111, v45, v101, v111
    v_dot2_f32_bf16 v111, v46, v102, v111
    v_dot2_f32_bf16 v111, v47, v103, v111
    v_add_f32_dpp v104, v104, v104 quad_perm:[1,0,3,2] row_mask:0xf bank_mask:0xf
    v_add_f32_dpp v105, v105, v105 quad_perm:[1,0,3,2] row_mask:0xf bank_mask:0xf
    v_add_f32_dpp v106, v106, v106 quad_perm:[1,0,3,2] row_mask:0xf bank_mask:0xf
    v_add_f32_dpp v107, v107, v107 quad_perm:[1,0,3,2] row_mask:0xf bank_mask:0xf
    v_add_f32_dpp v108, v108, v108 quad_perm:[1,0,3,2] row_mask:0xf bank_mask:0xf
    v_add_f32_dpp v109, v109, v109 quad_perm:[1,0,3,2] row_mask:0xf bank_mask:0xf
    v_add_f32_dpp v110, v110, v110 quad_perm:[1,0,3,2] row_mask:0xf bank_mask:0xf
    v_add_f32_dpp v111, v111, v111 quad_perm:[1,0,3,2] row_mask:0xf bank_mask:0xf
    v_add_f32_dpp v104, v104, v104 quad_perm:[2,3,0,1] row_mask:0xf bank_mask:0xf
    v_add_f32_dpp v105, v105, v105 quad_perm:[2,3,0,1] row_mask:0xf bank_mask:0xf
    v_add_f32_dpp v106, v106, v106 quad_perm:[2,3,0,1] row_mask:0xf bank_mask:0xf
    v_add_f32_dpp v107, v107, v107 quad_perm:[2,3,0,1] row_mask:0xf bank_mask:0xf
    v_add_f32_dpp v108, v108, v108 quad_perm:[2,3,0,1] row_mask:0xf bank_mask:0xf
    v_add_f32_dpp v109, v109, v109 quad_perm:[2,3,0,1] row_mask:0xf bank_mask:0xf
    v_add_f32_dpp v110, v110, v110 quad_perm:[2,3,0,1] row_mask:0xf bank_mask:0xf
    v_add_f32_dpp v111, v111, v111 quad_perm:[2,3,0,1] row_mask:0xf bank_mask:0xf
    v_add_f32_dpp v104, v104, v104 row_ror:4 row_mask:0xf bank_mask:0xf
    v_add_f32_dpp v105, v105, v105 row_ror:4 row_mask:0xf bank_mask:0xf
    v_add_f32_dpp v106, v106, v106 row_ror:4 row_mask:0xf bank_mask:0xf
    v_add_f32_dpp v107, v107, v107 row_ror:4 row_mask:0xf bank_mask:0xf
    v_add_f32_dpp v108, v108, v108 row_ror:4 row_mask:0xf bank_mask:0xf
    v_add_f32_dpp v109, v109, v109 row_ror:4 row_mask:0xf bank_mask:0xf
    v_add_f32_dpp v110, v110, v110 row_ror:4 row_mask:0xf bank_mask:0xf
    v_add_f32_dpp v111, v111, v111 row_ror:4 row_mask:0xf bank_mask:0xf
    v_add_f32_dpp v104, v104, v104 row_ror:8 row_mask:0xf bank_mask:0xf
    v_add_f32_dpp v105, v105, v105 row_ror:8 row_mask:0xf bank_mask:0xf
    v_add_f32_dpp v106, v106, v106 row_ror:8 row_mask:0xf bank_mask:0xf
    v_add_f32_dpp v107, v107, v107 row_ror:8 row_mask:0xf bank_mask:0xf
    v_add_f32_dpp v108, v108, v108 row_ror:8 row_mask:0xf bank_mask:0xf
    v_add_f32_dpp v109, v109, v109 row_ror:8 row_mask:0xf bank_mask:0xf
    v_add_f32_dpp v110, v110, v110 row_ror:8 row_mask:0xf bank_mask:0xf
    v_add_f32_dpp v111, v111, v111 row_ror:8 row_mask:0xf bank_mask:0xf
    v_max3_f32 v28, v104, v106, v108
    v_max3_f32 v28, v28, v110, v24
    v_sub_f32 v30, v24, v28
    v_mul_f32 v30, s20, v30
    v_mul_f32 v120, s20, v28
    v_exp_f32 v30, v30
    v_mov_b32 v24, v28
    v_fma_f32 v104, v104, s20, -v120
    v_fma_f32 v106, v106, s20, -v120
    v_fma_f32 v108, v108, s20, -v120
    v_fma_f32 v110, v110, s20, -v120
    v_exp_f32 v104, v104
    v_exp_f32 v106, v106
    v_exp_f32 v108, v108
    v_exp_f32 v110, v110
    v_mul_f32 v26, v26, v30
    v_mul_f32 v8, v8, v30
    v_mul_f32 v9, v9, v30
    v_mul_f32 v10, v10, v30
    v_mul_f32 v11, v11, v30
    v_mul_f32 v12, v12, v30
    v_mul_f32 v13, v13, v30
    v_mul_f32 v14, v14, v30
    v_mul_f32 v15, v15, v30
    v_add_f32 v28, v104, v106
    v_add_f32 v26, v26, v28
    v_add_f32 v28, v108, v110
    v_add_f32 v26, v26, v28
    v_max3_f32 v29, v105, v107, v109
    v_max3_f32 v29, v29, v111, v25
    v_sub_f32 v31, v25, v29
    v_mul_f32 v31, s20, v31
    v_mul_f32 v121, s20, v29
    v_exp_f32 v31, v31
    v_mov_b32 v25, v29
    v_fma_f32 v105, v105, s20, -v121
    v_fma_f32 v107, v107, s20, -v121
    v_fma_f32 v109, v109, s20, -v121
    v_fma_f32 v111, v111, s20, -v121
    v_exp_f32 v105, v105
    v_exp_f32 v107, v107
    v_exp_f32 v109, v109
    v_exp_f32 v111, v111
    v_mul_f32 v27, v27, v31
    v_mul_f32 v16, v16, v31
    v_mul_f32 v17, v17, v31
    v_mul_f32 v18, v18, v31
    v_mul_f32 v19, v19, v31
    v_mul_f32 v20, v20, v31
    v_mul_f32 v21, v21, v31
    v_mul_f32 v22, v22, v31
    v_mul_f32 v23, v23, v31
    v_add_f32 v29, v105, v107
    v_add_f32 v27, v27, v29
    v_add_f32 v29, v109, v111
    v_add_f32 v27, v27, v29
    s_waitcnt vmcnt(16)
    v_lshlrev_b32 v112, 16, v48
    v_and_b32 v113, 0xffff0000, v48
    v_lshlrev_b32 v114, 16, v49
    v_and_b32 v115, 0xffff0000, v49
    v_lshlrev_b32 v116, 16, v50
    v_and_b32 v117, 0xffff0000, v50
    v_lshlrev_b32 v118, 16, v51
    v_and_b32 v119, 0xffff0000, v51
    v_fmac_f32 v8, v104, v112
    v_fmac_f32 v16, v105, v112
    v_fmac_f32 v9, v104, v113
    v_fmac_f32 v17, v105, v113
    v_fmac_f32 v10, v104, v114
    v_fmac_f32 v18, v105, v114
    v_fmac_f32 v11, v104, v115
    v_fmac_f32 v19, v105, v115
    v_fmac_f32 v12, v104, v116
    v_fmac_f32 v20, v105, v116
    v_fmac_f32 v13, v104, v117
    v_fmac_f32 v21, v105, v117
    v_fmac_f32 v14, v104, v118
    v_fmac_f32 v22, v105, v118
    v_fmac_f32 v15, v104, v119
    v_fmac_f32 v23, v105, v119
    v_lshlrev_b32 v112, 16, v52
    v_and_b32 v113, 0xffff0000, v52
    v_lshlrev_b32 v114, 16, v53
    v_and_b32 v115, 0xffff0000, v53
    v_lshlrev_b32 v116, 16, v54
    v_and_b32 v117, 0xffff0000, v54
    v_lshlrev_b32 v118, 16, v55
    v_and_b32 v119, 0xffff0000, v55
    v_fmac_f32 v8, v106, v112
    v_fmac_f32 v16, v107, v112
    v_fmac_f32 v9, v106, v113
    v_fmac_f32 v17, v107, v113
    v_fmac_f32 v10, v106, v114
    v_fmac_f32 v18, v107, v114
    v_fmac_f32 v11, v106, v115
    v_fmac_f32 v19, v107, v115
    v_fmac_f32 v12, v106, v116
    v_fmac_f32 v20, v107, v116
    v_fmac_f32 v13, v106, v117
    v_fmac_f32 v21, v107, v117
    v_fmac_f32 v14, v106, v118
    v_fmac_f32 v22, v107, v118
    v_fmac_f32 v15, v106, v119
    v_fmac_f32 v23, v107, v119
    v_lshlrev_b32 v112, 16, v56
    v_and_b32 v113, 0xffff0000, v56
    v_lshlrev_b32 v114, 16, v57
    v_and_b32 v115, 0xffff0000, v57
    v_lshlrev_b32 v116, 16, v58
    v_and_b32 v117, 0xffff0000, v58
    v_lshlrev_b32 v118, 16, v59
    v_and_b32 v119, 0xffff0000, v59
    v_fmac_f32 v8, v108, v112
    v_fmac_f32 v16, v109, v112
    v_fmac_f32 v9, v108, v113
    v_fmac_f32 v17, v109, v113
    v_fmac_f32 v10, v108, v114
    v_fmac_f32 v18, v109, v114
    v_fmac_f32 v11, v108, v115
    v_fmac_f32 v19, v109, v115
    v_fmac_f32 v12, v108, v116
    v_fmac_f32 v20, v109, v116
    v_fmac_f32 v13, v108, v117
    v_fmac_f32 v21, v109, v117
    v_fmac_f32 v14, v108, v118
    v_fmac_f32 v22, v109, v118
    v_fmac_f32 v15, v108, v119
    v_fmac_f32 v23, v109, v119
    v_lshlrev_b32 v112, 16, v60
    v_and_b32 v113, 0xffff0000, v60
    v_lshlrev_b32 v114, 16, v61
    v_and_b32 v115, 0xffff0000, v61
    v_lshlrev_b32 v116, 16, v62
    v_and_b32 v117, 0xffff0000, v62
    v_lshlrev_b32 v118, 16, v63
    v_and_b32 v119, 0xffff0000, v63
    v_fmac_f32 v8, v110, v112
    v_fmac_f32 v16, v111, v112
    v_fmac_f32 v9, v110, v113
    v_fmac_f32 v17, v111, v113
    v_fmac_f32 v10, v110, v114
    v_fmac_f32 v18, v111, v114
    v_fmac_f32 v11, v110, v115
    v_fmac_f32 v19, v111, v115
    v_fmac_f32 v12, v110, v116
    v_fmac_f32 v20, v111, v116
    v_fmac_f32 v13, v110, v117
    v_fmac_f32 v21, v111, v117
    v_fmac_f32 v14, v110, v118
    v_fmac_f32 v22, v111, v118
    v_fmac_f32 v15, v110, v119
    v_fmac_f32 v23, v111, v119
    global_load_dwordx4 v[32:35], v2, s[4:5] offset:0 nt
    global_load_dwordx4 v[36:39], v2, s[4:5] offset:1024 nt
    global_load_dwordx4 v[40:43], v2, s[4:5] offset:2048 nt
    global_load_dwordx4 v[44:47], v2, s[4:5] offset:3072 nt
    global_load_dwordx4 v[48:51], v2, s[6:7] offset:0 nt
    global_load_dwordx4 v[52:55], v2, s[6:7] offset:1024 nt
    global_load_dwordx4 v[56:59], v2, s[6:7] offset:2048 nt
    global_load_dwordx4 v[60:63], v2, s[6:7] offset:3072 nt
    s_add_u32 s4, s4, 32768
    s_addc_u32 s5, s5, 0
    s_add_u32 s6, s6, 32768
    s_addc_u32 s7, s7, 0
    s_waitcnt vmcnt(20)
    v_dot2_f32_bf16 v104, v64, v96, 0
    v_dot2_f32_bf16 v104, v65, v97, v104
    v_dot2_f32_bf16 v104, v66, v98, v104
    v_dot2_f32_bf16 v104, v67, v99, v104
    v_dot2_f32_bf16 v105, v64, v100, 0
    v_dot2_f32_bf16 v105, v65, v101, v105
    v_dot2_f32_bf16 v105, v66, v102, v105
    v_dot2_f32_bf16 v105, v67, v103, v105
    v_dot2_f32_bf16 v106, v68, v96, 0
    v_dot2_f32_bf16 v106, v69, v97, v106
    v_dot2_f32_bf16 v106, v70, v98, v106
    v_dot2_f32_bf16 v106, v71, v99, v106
    v_dot2_f32_bf16 v107, v68, v100, 0
    v_dot2_f32_bf16 v107, v69, v101, v107
    v_dot2_f32_bf16 v107, v70, v102, v107
    v_dot2_f32_bf16 v107, v71, v103, v107
    v_dot2_f32_bf16 v108, v72, v96, 0
    v_dot2_f32_bf16 v108, v73, v97, v108
    v_dot2_f32_bf16 v108, v74, v98, v108
    v_dot2_f32_bf16 v108, v75, v99, v108
    v_dot2_f32_bf16 v109, v72, v100, 0
    v_dot2_f32_bf16 v109, v73, v101, v109
    v_dot2_f32_bf16 v109, v74, v102, v109
    v_dot2_f32_bf16 v109, v75, v103, v109
    v_dot2_f32_bf16 v110, v76, v96, 0
    v_dot2_f32_bf16 v110, v77, v97, v110
    v_dot2_f32_bf16 v110, v78, v98, v110
    v_dot2_f32_bf16 v110, v79, v99, v110
    v_dot2_f32_bf16 v111, v76, v100, 0
    v_dot2_f32_bf16 v111, v77, v101, v111
    v_dot2_f32_bf16 v111, v78, v102, v111
    v_dot2_f32_bf16 v111, v79, v103, v111
    v_add_f32_dpp v104, v104, v104 quad_perm:[1,0,3,2] row_mask:0xf bank_mask:0xf
    v_add_f32_dpp v105, v105, v105 quad_perm:[1,0,3,2] row_mask:0xf bank_mask:0xf
    v_add_f32_dpp v106, v106, v106 quad_perm:[1,0,3,2] row_mask:0xf bank_mask:0xf
    v_add_f32_dpp v107, v107, v107 quad_perm:[1,0,3,2] row_mask:0xf bank_mask:0xf
    v_add_f32_dpp v108, v108, v108 quad_perm:[1,0,3,2] row_mask:0xf bank_mask:0xf
    v_add_f32_dpp v109, v109, v109 quad_perm:[1,0,3,2] row_mask:0xf bank_mask:0xf
    v_add_f32_dpp v110, v110, v110 quad_perm:[1,0,3,2] row_mask:0xf bank_mask:0xf
    v_add_f32_dpp v111, v111, v111 quad_perm:[1,0,3,2] row_mask:0xf bank_mask:0xf
    v_add_f32_dpp v104, v104, v104 quad_perm:[2,3,0,1] row_mask:0xf bank_mask:0xf
    v_add_f32_dpp v105, v105, v105 quad_perm:[2,3,0,1] row_mask:0xf bank_mask:0xf
    v_add_f32_dpp v106, v106, v106 quad_perm:[2,3,0,1] row_mask:0xf bank_mask:0xf
    v_add_f32_dpp v107, v107, v107 quad_perm:[2,3,0,1] row_mask:0xf bank_mask:0xf
    v_add_f32_dpp v108, v108, v108 quad_perm:[2,3,0,1] row_mask:0xf bank_mask:0xf
    v_add_f32_dpp v109, v109, v109 quad_perm:[2,3,0,1] row_mask:0xf bank_mask:0xf
    v_add_f32_dpp v110, v110, v110 quad_perm:[2,3,0,1] row_mask:0xf bank_mask:0xf
    v_add_f32_dpp v111, v111, v111 quad_perm:[2,3,0,1] row_mask:0xf bank_mask:0xf
    v_add_f32_dpp v104, v104, v104 row_ror:4 row_mask:0xf bank_mask:0xf
    v_add_f32_dpp v105, v105, v105 row_ror:4 row_mask:0xf bank_mask:0xf
    v_add_f32_dpp v106, v106, v106 row_ror:4 row_mask:0xf bank_mask:0xf
    v_add_f32_dpp v107, v107, v107 row_ror:4 row_mask:0xf bank_mask:0xf
    v_add_f32_dpp v108, v108, v108 row_ror:4 row_mask:0xf bank_mask:0xf
    v_add_f32_dpp v109, v109, v109 row_ror:4 row_mask:0xf bank_mask:0xf
    v_add_f32_dpp v110, v110, v110 row_ror:4 row_mask:0xf bank_mask:0xf
    v_add_f32_dpp v111, v111, v111 row_ror:4 row_mask:0xf bank_mask:0xf
    v_add_f32_dpp v104, v104, v104 row_ror:8 row_mask:0xf bank_mask:0xf
    v_add_f32_dpp v105, v105, v105 row_ror:8 row_mask:0xf bank_mask:0xf
    v_add_f32_dpp v106, v106, v106 row_ror:8 row_mask:0xf bank_mask:0xf
    v_add_f32_dpp v107, v107, v107 row_ror:8 row_mask:0xf bank_mask:0xf
    v_add_f32_dpp v108, v108, v108 row_ror:8 row_mask:0xf bank_mask:0xf
    v_add_f32_dpp v109, v109, v109 row_ror:8 row_mask:0xf bank_mask:0xf
    v_add_f32_dpp v110, v110, v110 row_ror:8 row_mask:0xf bank_mask:0xf
    v_add_f32_dpp v111, v111, v111 row_ror:8 row_mask:0xf bank_mask:0xf
    v_max3_f32 v28, v104, v106, v108
    v_max3_f32 v28, v28, v110, v24
    v_sub_f32 v30, v24, v28
    v_mul_f32 v30, s20, v30
    v_mul_f32 v120, s20, v28
    v_exp_f32 v30, v30
    v_mov_b32 v24, v28
    v_fma_f32 v104, v104, s20, -v120
    v_fma_f32 v106, v106, s20, -v120
    v_fma_f32 v108, v108, s20, -v120
    v_fma_f32 v110, v110, s20, -v120
    v_exp_f32 v104, v104
    v_exp_f32 v106, v106
    v_exp_f32 v108, v108
    v_exp_f32 v110, v110
    v_mul_f32 v26, v26, v30
    v_mul_f32 v8, v8, v30
    v_mul_f32 v9, v9, v30
    v_mul_f32 v10, v10, v30
    v_mul_f32 v11, v11, v30
    v_mul_f32 v12, v12, v30
    v_mul_f32 v13, v13, v30
    v_mul_f32 v14, v14, v30
    v_mul_f32 v15, v15, v30
    v_add_f32 v28, v104, v106
    v_add_f32 v26, v26, v28
    v_add_f32 v28, v108, v110
    v_add_f32 v26, v26, v28
    v_max3_f32 v29, v105, v107, v109
    v_max3_f32 v29, v29, v111, v25
    v_sub_f32 v31, v25, v29
    v_mul_f32 v31, s20, v31
    v_mul_f32 v121, s20, v29
    v_exp_f32 v31, v31
    v_mov_b32 v25, v29
    v_fma_f32 v105, v105, s20, -v121
    v_fma_f32 v107, v107, s20, -v121
    v_fma_f32 v109, v109, s20, -v121
    v_fma_f32 v111, v111, s20, -v121
    v_exp_f32 v105, v105
    v_exp_f32 v107, v107
    v_exp_f32 v109, v109
    v_exp_f32 v111, v111
    v_mul_f32 v27, v27, v31
    v_mul_f32 v16, v16, v31
    v_mul_f32 v17, v17, v31
    v_mul_f32 v18, v18, v31
    v_mul_f32 v19, v19, v31
    v_mul_f32 v20, v20, v31
    v_mul_f32 v21, v21, v31
    v_mul_f32 v22, v22, v31
    v_mul_f32 v23, v23, v31
    v_add_f32 v29, v105, v107
    v_add_f32 v27, v27, v29
    v_add_f32 v29, v109, v111
    v_add_f32 v27, v27, v29
    s_waitcnt vmcnt(16)
    v_lshlrev_b32 v112, 16, v80
    v_and_b32 v113, 0xffff0000, v80
    v_lshlrev_b32 v114, 16, v81
    v_and_b32 v115, 0xffff0000, v81
    v_lshlrev_b32 v116, 16, v82
    v_and_b32 v117, 0xffff0000, v82
    v_lshlrev_b32 v118, 16, v83
    v_and_b32 v119, 0xffff0000, v83
    v_fmac_f32 v8, v104, v112
    v_fmac_f32 v16, v105, v112
    v_fmac_f32 v9, v104, v113
    v_fmac_f32 v17, v105, v113
    v_fmac_f32 v10, v104, v114
    v_fmac_f32 v18, v105, v114
    v_fmac_f32 v11, v104, v115
    v_fmac_f32 v19, v105, v115
    v_fmac_f32 v12, v104, v116
    v_fmac_f32 v20, v105, v116
    v_fmac_f32 v13, v104, v117
    v_fmac_f32 v21, v105, v117
    v_fmac_f32 v14, v104, v118
    v_fmac_f32 v22, v105, v118
    v_fmac_f32 v15, v104, v119
    v_fmac_f32 v23, v105, v119
    v_lshlrev_b32 v112, 16, v84
    v_and_b32 v113, 0xffff0000, v84
    v_lshlrev_b32 v114, 16, v85
    v_and_b32 v115, 0xffff0000, v85
    v_lshlrev_b32 v116, 16, v86
    v_and_b32 v117, 0xffff0000, v86
    v_lshlrev_b32 v118, 16, v87
    v_and_b32 v119, 0xffff0000, v87
    v_fmac_f32 v8, v106, v112
    v_fmac_f32 v16, v107, v112
    v_fmac_f32 v9, v106, v113
    v_fmac_f32 v17, v107, v113
    v_fmac_f32 v10, v106, v114
    v_fmac_f32 v18, v107, v114
    v_fmac_f32 v11, v106, v115
    v_fmac_f32 v19, v107, v115
    v_fmac_f32 v12, v106, v116
    v_fmac_f32 v20, v107, v116
    v_fmac_f32 v13, v106, v117
    v_fmac_f32 v21, v107, v117
    v_fmac_f32 v14, v106, v118
    v_fmac_f32 v22, v107, v118
    v_fmac_f32 v15, v106, v119
    v_fmac_f32 v23, v107, v119
    v_lshlrev_b32 v112, 16, v88
    v_and_b32 v113, 0xffff0000, v88
    v_lshlrev_b32 v114, 16, v89
    v_and_b32 v115, 0xffff0000, v89
    v_lshlrev_b32 v116, 16, v90
    v_and_b32 v117, 0xffff0000, v90
    v_lshlrev_b32 v118, 16, v91
    v_and_b32 v119, 0xffff0000, v91
    v_fmac_f32 v8, v108, v112
    v_fmac_f32 v16, v109, v112
    v_fmac_f32 v9, v108, v113
    v_fmac_f32 v17, v109, v113
    v_fmac_f32 v10, v108, v114
    v_fmac_f32 v18, v109, v114
    v_fmac_f32 v11, v108, v115
    v_fmac_f32 v19, v109, v115
    v_fmac_f32 v12, v108, v116
    v_fmac_f32 v20, v109, v116
    v_fmac_f32 v13, v108, v117
    v_fmac_f32 v21, v109, v117
    v_fmac_f32 v14, v108, v118
    v_fmac_f32 v22, v109, v118
    v_fmac_f32 v15, v108, v119
    v_fmac_f32 v23, v109, v119
    v_lshlrev_b32 v112, 16, v92
    v_and_b32 v113, 0xffff0000, v92
    v_lshlrev_b32 v114, 16, v93
    v_and_b32 v115, 0xffff0000, v93
    v_lshlrev_b32 v116, 16, v94
    v_and_b32 v117, 0xffff0000, v94
    v_lshlrev_b32 v118, 16, v95
    v_and_b32 v119, 0xffff0000, v95
    v_fmac_f32 v8, v110, v112
    v_fmac_f32 v16, v111, v112
    v_fmac_f32 v9, v110, v113
    v_fmac_f32 v17, v111, v113
    v_fmac_f32 v10, v110, v114
    v_fmac_f32 v18, v111, v114
    v_fmac_f32 v11, v110, v115
    v_fmac_f32 v19, v111, v115
    v_fmac_f32 v12, v110, v116
    v_fmac_f32 v20, v111, v116
    v_fmac_f32 v13, v110, v117
    v_fmac_f32 v21, v111, v117
    v_fmac_f32 v14, v110, v118
    v_fmac_f32 v22, v111, v118
    v_fmac_f32 v15, v110, v119
    v_fmac_f32 v23, v111, v119
    global_load_dwordx4 v[64:67], v2, s[4:5] offset:0 nt
    global_load_dwordx4 v[68:71], v2, s[4:5] offset:1024 nt
    global_load_dwordx4 v[72:75], v2, s[4:5] offset:2048 nt
    global_load_dwordx4 v[76:79], v2, s[4:5] offset:3072 nt
    global_load_dwordx4 v[80:83], v2, s[6:7] offset:0 nt
    global_load_dwordx4 v[84:87], v2, s[6:7] offset:1024 nt
    global_load_dwordx4 v[88:91], v2, s[6:7] offset:2048 nt
    global_load_dwordx4 v[92:95], v2, s[6:7] offset:3072 nt
    s_add_u32 s4, s4, 32768
    s_addc_u32 s5, s5, 0
    s_add_u32 s6, s6, 32768
    s_addc_u32 s7, s7, 0
    s_waitcnt vmcnt(20)
    v_dot2_f32_bf16 v104, v128, v96, 0
    v_dot2_f32_bf16 v104, v129, v97, v104
    v_dot2_f32_bf16 v104, v130, v98, v104
    v_dot2_f32_bf16 v104, v131, v99, v104
    v_dot2_f32_bf16 v105, v128, v100, 0
    v_dot2_f32_bf16 v105, v129, v101, v105
    v_dot2_f32_bf16 v105, v130, v102, v105
    v_dot2_f32_bf16 v105, v131, v103, v105
    v_dot2_f32_bf16 v106, v132, v96, 0
    v_dot2_f32_bf16 v106, v133, v97, v106
    v_dot2_f32_bf16 v106, v134, v98, v106
    v_dot2_f32_bf16 v106, v135, v99, v106
    v_dot2_f32_bf16 v107, v132, v100, 0
    v_dot2_f32_bf16 v107, v133, v101, v107
    v_dot2_f32_bf16 v107, v134, v102, v107
    v_dot2_f32_bf16 v107, v135, v103, v107
    v_dot2_f32_bf16 v108, v136, v96, 0
    v_dot2_f32_bf16 v108, v137, v97, v108
    v_dot2_f32_bf16 v108, v138, v98, v108
    v_dot2_f32_bf16 v108, v139, v99, v108
    v_dot2_f32_bf16 v109, v136, v100, 0
    v_dot2_f32_bf16 v109, v137, v101, v109
    v_dot2_f32_bf16 v109, v138, v102, v109
    v_dot2_f32_bf16 v109, v139, v103, v109
    v_dot2_f32_bf16 v110, v140, v96, 0
    v_dot2_f32_bf16 v110, v141, v97, v110
    v_dot2_f32_bf16 v110, v142, v98, v110
    v_dot2_f32_bf16 v110, v143, v99, v110
    v_dot2_f32_bf16 v111, v140, v100, 0
    v_dot2_f32_bf16 v111, v141, v101, v111
    v_dot2_f32_bf16 v111, v142, v102, v111
    v_dot2_f32_bf16 v111, v143, v103, v111
    v_add_f32_dpp v104, v104, v104 quad_perm:[1,0,3,2] row_mask:0xf bank_mask:0xf
    v_add_f32_dpp v105, v105, v105 quad_perm:[1,0,3,2] row_mask:0xf bank_mask:0xf
    v_add_f32_dpp v106, v106, v106 quad_perm:[1,0,3,2] row_mask:0xf bank_mask:0xf
    v_add_f32_dpp v107, v107, v107 quad_perm:[1,0,3,2] row_mask:0xf bank_mask:0xf
    v_add_f32_dpp v108, v108, v108 quad_perm:[1,0,3,2] row_mask:0xf bank_mask:0xf
    v_add_f32_dpp v109, v109, v109 quad_perm:[1,0,3,2] row_mask:0xf bank_mask:0xf
    v_add_f32_dpp v110, v110, v110 quad_perm:[1,0,3,2] row_mask:0xf bank_mask:0xf
    v_add_f32_dpp v111, v111, v111 quad_perm:[1,0,3,2] row_mask:0xf bank_mask:0xf
    v_add_f32_dpp v104, v104, v104 quad_perm:[2,3,0,1] row_mask:0xf bank_mask:0xf
    v_add_f32_dpp v105, v105, v105 quad_perm:[2,3,0,1] row_mask:0xf bank_mask:0xf
    v_add_f32_dpp v106, v106, v106 quad_perm:[2,3,0,1] row_mask:0xf bank_mask:0xf
    v_add_f32_dpp v107, v107, v107 quad_perm:[2,3,0,1] row_mask:0xf bank_mask:0xf
    v_add_f32_dpp v108, v108, v108 quad_perm:[2,3,0,1] row_mask:0xf bank_mask:0xf
    v_add_f32_dpp v109, v109, v109 quad_perm:[2,3,0,1] row_mask:0xf bank_mask:0xf
    v_add_f32_dpp v110, v110, v110 quad_perm:[2,3,0,1] row_mask:0xf bank_mask:0xf
    v_add_f32_dpp v111, v111, v111 quad_perm:[2,3,0,1] row_mask:0xf bank_mask:0xf
    v_add_f32_dpp v104, v104, v104 row_ror:4 row_mask:0xf bank_mask:0xf
    v_add_f32_dpp v105, v105, v105 row_ror:4 row_mask:0xf bank_mask:0xf
    v_add_f32_dpp v106, v106, v106 row_ror:4 row_mask:0xf bank_mask:0xf
    v_add_f32_dpp v107, v107, v107 row_ror:4 row_mask:0xf bank_mask:0xf
    v_add_f32_dpp v108, v108, v108 row_ror:4 row_mask:0xf bank_mask:0xf
    v_add_f32_dpp v109, v109, v109 row_ror:4 row_mask:0xf bank_mask:0xf
    v_add_f32_dpp v110, v110, v110 row_ror:4 row_mask:0xf bank_mask:0xf
    v_add_f32_dpp v111, v111, v111 row_ror:4 row_mask:0xf bank_mask:0xf
    v_add_f32_dpp v104, v104, v104 row_ror:8 row_mask:0xf bank_mask:0xf
    v_add_f32_dpp v105, v105, v105 row_ror:8 row_mask:0xf bank_mask:0xf
    v_add_f32_dpp v106, v106, v106 row_ror:8 row_mask:0xf bank_mask:0xf
    v_add_f32_dpp v107, v107, v107 row_ror:8 row_mask:0xf bank_mask:0xf
    v_add_f32_dpp v108, v108, v108 row_ror:8 row_mask:0xf bank_mask:0xf
    v_add_f32_dpp v109, v109, v109 row_ror:8 row_mask:0xf bank_mask:0xf
    v_add_f32_dpp v110, v110, v110 row_ror:8 row_mask:0xf bank_mask:0xf
    v_add_f32_dpp v111, v111, v111 row_ror:8 row_mask:0xf bank_mask:0xf
    v_max3_f32 v28, v104, v106, v108
    v_max3_f32 v28, v28, v110, v24
    v_sub_f32 v30, v24, v28
    v_mul_f32 v30, s20, v30
    v_mul_f32 v120, s20, v28
    v_exp_f32 v30, v30
    v_mov_b32 v24, v28
    v_fma_f32 v104, v104, s20, -v120
    v_fma_f32 v106, v106, s20, -v120
    v_fma_f32 v108, v108, s20, -v120
    v_fma_f32 v110, v110, s20, -v120
    v_exp_f32 v104, v104
    v_exp_f32 v106, v106
    v_exp_f32 v108, v108
    v_exp_f32 v110, v110
    v_mul_f32 v26, v26, v30
    v_mul_f32 v8, v8, v30
    v_mul_f32 v9, v9, v30
    v_mul_f32 v10, v10, v30
    v_mul_f32 v11, v11, v30
    v_mul_f32 v12, v12, v30
    v_mul_f32 v13, v13, v30
    v_mul_f32 v14, v14, v30
    v_mul_f32 v15, v15, v30
    v_add_f32 v28, v104, v106
    v_add_f32 v26, v26, v28
    v_add_f32 v28, v108, v110
    v_add_f32 v26, v26, v28
    v_max3_f32 v29, v105, v107, v109
    v_max3_f32 v29, v29, v111, v25
    v_sub_f32 v31, v25, v29
    v_mul_f32 v31, s20, v31
    v_mul_f32 v121, s20, v29
    v_exp_f32 v31, v31
    v_mov_b32 v25, v29
    v_fma_f32 v105, v105, s20, -v121
    v_fma_f32 v107, v107, s20, -v121
    v_fma_f32 v109, v109, s20, -v121
    v_fma_f32 v111, v111, s20, -v121
    v_exp_f32 v105, v105
    v_exp_f32 v107, v107
    v_exp_f32 v109, v109
    v_exp_f32 v111, v111
    v_mul_f32 v27, v27, v31
    v_mul_f32 v16, v16, v31
    v_mul_f32 v17, v17, v31
    v_mul_f32 v18, v18, v31
    v_mul_f32 v19, v19, v31
    v_mul_f32 v20, v20, v31
    v_mul_f32 v21, v21, v31
    v_mul_f32 v22, v22, v31
    v_mul_f32 v23, v23, v31
    v_add_f32 v29, v105, v107
    v_add_f32 v27, v27, v29
    v_add_f32 v29, v109, v111
    v_add_f32 v27, v27, v29
    s_waitcnt vmcnt(16)
    v_lshlrev_b32 v112, 16, v144
    v_and_b32 v113, 0xffff0000, v144
    v_lshlrev_b32 v114, 16, v145
    v_and_b32 v115, 0xffff0000, v145
    v_lshlrev_b32 v116, 16, v146
    v_and_b32 v117, 0xffff0000, v146
    v_lshlrev_b32 v118, 16, v147
    v_and_b32 v119, 0xffff0000, v147
    v_fmac_f32 v8, v104, v112
    v_fmac_f32 v16, v105, v112
    v_fmac_f32 v9, v104, v113
    v_fmac_f32 v17, v105, v113
    v_fmac_f32 v10, v104, v114
    v_fmac_f32 v18, v105, v114
    v_fmac_f32 v11, v104, v115
    v_fmac_f32 v19, v105, v115
    v_fmac_f32 v12, v104, v116
    v_fmac_f32 v20, v105, v116
    v_fmac_f32 v13, v104, v117
    v_fmac_f32 v21, v105, v117
    v_fmac_f32 v14, v104, v118
    v_fmac_f32 v22, v105, v118
    v_fmac_f32 v15, v104, v119
    v_fmac_f32 v23, v105, v119
    v_lshlrev_b32 v112, 16, v148
    v_and_b32 v113, 0xffff0000, v148
    v_lshlrev_b32 v114, 16, v149
    v_and_b32 v115, 0xffff0000, v149
    v_lshlrev_b32 v116, 16, v150
    v_and_b32 v117, 0xffff0000, v150
    v_lshlrev_b32 v118, 16, v151
    v_and_b32 v119, 0xffff0000, v151
    v_fmac_f32 v8, v106, v112
    v_fmac_f32 v16, v107, v112
    v_fmac_f32 v9, v106, v113
    v_fmac_f32 v17, v107, v113
    v_fmac_f32 v10, v106, v114
    v_fmac_f32 v18, v107, v114
    v_fmac_f32 v11, v106, v115
    v_fmac_f32 v19, v107, v115
    v_fmac_f32 v12, v106, v116
    v_fmac_f32 v20, v107, v116
    v_fmac_f32 v13, v106, v117
    v_fmac_f32 v21, v107, v117
    v_fmac_f32 v14, v106, v118
    v_fmac_f32 v22, v107, v118
    v_fmac_f32 v15, v106, v119
    v_fmac_f32 v23, v107, v119
    v_lshlrev_b32 v112, 16, v152
    v_and_b32 v113, 0xffff0000, v152
    v_lshlrev_b32 v114, 16, v153
    v_and_b32 v115, 0xffff0000, v153
    v_lshlrev_b32 v116, 16, v154
    v_and_b32 v117, 0xffff0000, v154
    v_lshlrev_b32 v118, 16, v155
    v_and_b32 v119, 0xffff0000, v155
    v_fmac_f32 v8, v108, v112
    v_fmac_f32 v16, v109, v112
    v_fmac_f32 v9, v108, v113
    v_fmac_f32 v17, v109, v113
    v_fmac_f32 v10, v108, v114
    v_fmac_f32 v18, v109, v114
    v_fmac_f32 v11, v108, v115
    v_fmac_f32 v19, v109, v115
    v_fmac_f32 v12, v108, v116
    v_fmac_f32 v20, v109, v116
    v_fmac_f32 v13, v108, v117
    v_fmac_f32 v21, v109, v117
    v_fmac_f32 v14, v108, v118
    v_fmac_f32 v22, v109, v118
    v_fmac_f32 v15, v108, v119
    v_fmac_f32 v23, v109, v119
    v_lshlrev_b32 v112, 16, v156
    v_and_b32 v113, 0xffff0000, v156
    v_lshlrev_b32 v114, 16, v157
    v_and_b32 v115, 0xffff0000, v157
    v_lshlrev_b32 v116, 16, v158
    v_and_b32 v117, 0xffff0000, v158
    v_lshlrev_b32 v118, 16, v159
    v_and_b32 v119, 0xffff0000, v159
    v_fmac_f32 v8, v110, v112
    v_fmac_f32 v16, v111, v112
    v_fmac_f32 v9, v110, v113
    v_fmac_f32 v17, v111, v113
    v_fmac_f32 v10, v110, v114
    v_fmac_f32 v18, v111, v114
    v_fmac_f32 v11, v110, v115
    v_fmac_f32 v19, v111, v115
    v_fmac_f32 v12, v110, v116
    v_fmac_f32 v20, v111, v116
    v_fmac_f32 v13, v110, v117
    v_fmac_f32 v21, v111, v117
    v_fmac_f32 v14, v110, v118
    v_fmac_f32 v22, v111, v118
    v_fmac_f32 v15, v110, v119
    v_fmac_f32 v23, v111, v119
    s_waitcnt vmcnt(12)
    v_dot2_f32_bf16 v104, v32, v96, 0
    v_dot2_f32_bf16 v104, v33, v97, v104
    v_dot2_f32_bf16 v104, v34, v98, v104
    v_dot2_f32_bf16 v104, v35, v99, v104
    v_dot2_f32_bf16 v105, v32, v100, 0
    v_dot2_f32_bf16 v105, v33, v101, v105
    v_dot2_f32_bf16 v105, v34, v102, v105
    v_dot2_f32_bf16 v105, v35, v103, v105
    v_dot2_f32_bf16 v106, v36, v96, 0
    v_dot2_f32_bf16 v106, v37, v97, v106
    v_dot2_f32_bf16 v106, v38, v98, v106
    v_dot2_f32_bf16 v106, v39, v99, v106
    v_dot2_f32_bf16 v107, v36, v100, 0
    v_dot2_f32_bf16 v107, v37, v101, v107
    v_dot2_f32_bf16 v107, v38, v102, v107
    v_dot2_f32_bf16 v107, v39, v103, v107
    v_dot2_f32_bf16 v108, v40, v96, 0
    v_dot2_f32_bf16 v108, v41, v97, v108
    v_dot2_f32_bf16 v108, v42, v98, v108
    v_dot2_f32_bf16 v108, v43, v99, v108
    v_dot2_f32_bf16 v109, v40, v100, 0
    v_dot2_f32_bf16 v109, v41, v101, v109
    v_dot2_f32_bf16 v109, v42, v102, v109
    v_dot2_f32_bf16 v109, v43, v103, v109
    v_dot2_f32_bf16 v110, v44, v96, 0
    v_dot2_f32_bf16 v110, v45, v97, v110
    v_dot2_f32_bf16 v110, v46, v98, v110
    v_dot2_f32_bf16 v110, v47, v99, v110
    v_dot2_f32_bf16 v111, v44, v100, 0
    v_dot2_f32_bf16 v111, v45, v101, v111
    v_dot2_f32_bf16 v111, v46, v102, v111
    v_dot2_f32_bf16 v111, v47, v103, v111
    v_add_f32_dpp v104, v104, v104 quad_perm:[1,0,3,2] row_mask:0xf bank_mask:0xf
    v_add_f32_dpp v105, v105, v105 quad_perm:[1,0,3,2] row_mask:0xf bank_mask:0xf
    v_add_f32_dpp v106, v106, v106 quad_perm:[1,0,3,2] row_mask:0xf bank_mask:0xf
    v_add_f32_dpp v107, v107, v107 quad_perm:[1,0,3,2] row_mask:0xf bank_mask:0xf
    v_add_f32_dpp v108, v108, v108 quad_perm:[1,0,3,2] row_mask:0xf bank_mask:0xf
    v_add_f32_dpp v109, v109, v109 quad_perm:[1,0,3,2] row_mask:0xf bank_mask:0xf
    v_add_f32_dpp v110, v110, v110 quad_perm:[1,0,3,2] row_mask:0xf bank_mask:0xf
    v_add_f32_dpp v111, v111, v111 quad_perm:[1,0,3,2] row_mask:0xf bank_mask:0xf
    v_add_f32_dpp v104, v104, v104 quad_perm:[2,3,0,1] row_mask:0xf bank_mask:0xf
    v_add_f32_dpp v105, v105, v105 quad_perm:[2,3,0,1] row_mask:0xf bank_mask:0xf
    v_add_f32_dpp v106, v106, v106 quad_perm:[2,3,0,1] row_mask:0xf bank_mask:0xf
    v_add_f32_dpp v107, v107, v107 quad_perm:[2,3,0,1] row_mask:0xf bank_mask:0xf
    v_add_f32_dpp v108, v108, v108 quad_perm:[2,3,0,1] row_mask:0xf bank_mask:0xf
    v_add_f32_dpp v109, v109, v109 quad_perm:[2,3,0,1] row_mask:0xf bank_mask:0xf
    v_add_f32_dpp v110, v110, v110 quad_perm:[2,3,0,1] row_mask:0xf bank_mask:0xf
    v_add_f32_dpp v111, v111, v111 quad_perm:[2,3,0,1] row_mask:0xf bank_mask:0xf
    v_add_f32_dpp v104, v104, v104 row_ror:4 row_mask:0xf bank_mask:0xf
    v_add_f32_dpp v105, v105, v105 row_ror:4 row_mask:0xf bank_mask:0xf
    v_add_f32_dpp v106, v106, v106 row_ror:4 row_mask:0xf bank_mask:0xf
    v_add_f32_dpp v107, v107, v107 row_ror:4 row_mask:0xf bank_mask:0xf
    v_add_f32_dpp v108, v108, v108 row_ror:4 row_mask:0xf bank_mask:0xf
    v_add_f32_dpp v109, v109, v109 row_ror:4 row_mask:0xf bank_mask:0xf
    v_add_f32_dpp v110, v110, v110 row_ror:4 row_mask:0xf bank_mask:0xf
    v_add_f32_dpp v111, v111, v111 row_ror:4 row_mask:0xf bank_mask:0xf
    v_add_f32_dpp v104, v104, v104 row_ror:8 row_mask:0xf bank_mask:0xf
    v_add_f32_dpp v105, v105, v105 row_ror:8 row_mask:0xf bank_mask:0xf
    v_add_f32_dpp v106, v106, v106 row_ror:8 row_mask:0xf bank_mask:0xf
    v_add_f32_dpp v107, v107, v107 row_ror:8 row_mask:0xf bank_mask:0xf
    v_add_f32_dpp v108, v108, v108 row_ror:8 row_mask:0xf bank_mask:0xf
    v_add_f32_dpp v109, v109, v109 row_ror:8 row_mask:0xf bank_mask:0xf
    v_add_f32_dpp v110, v110, v110 row_ror:8 row_mask:0xf bank_mask:0xf
    v_add_f32_dpp v111, v111, v111 row_ror:8 row_mask:0xf bank_mask:0xf
    v_max3_f32 v28, v104, v106, v108
    v_max3_f32 v28, v28, v110, v24
    v_sub_f32 v30, v24, v28
    v_mul_f32 v30, s20, v30
    v_mul_f32 v120, s20, v28
    v_exp_f32 v30, v30
    v_mov_b32 v24, v28
    v_fma_f32 v104, v104, s20, -v120
    v_fma_f32 v106, v106, s20, -v120
    v_fma_f32 v108, v108, s20, -v120
    v_fma_f32 v110, v110, s20, -v120
    v_exp_f32 v104, v104
    v_exp_f32 v106, v106
    v_exp_f32 v108, v108
    v_exp_f32 v110, v110
    v_mul_f32 v26, v26, v30
    v_mul_f32 v8, v8, v30
    v_mul_f32 v9, v9, v30
    v_mul_f32 v10, v10, v30
    v_mul_f32 v11, v11, v30
    v_mul_f32 v12, v12, v30
    v_mul_f32 v13, v13, v30
    v_mul_f32 v14, v14, v30
    v_mul_f32 v15, v15, v30
    v_add_f32 v28, v104, v106
    v_add_f32 v26, v26, v28
    v_add_f32 v28, v108, v110
    v_add_f32 v26, v26, v28
    v_max3_f32 v29, v105, v107, v109
    v_max3_f32 v29, v29, v111, v25
    v_sub_f32 v31, v25, v29
    v_mul_f32 v31, s20, v31
    v_mul_f32 v121, s20, v29
    v_exp_f32 v31, v31
    v_mov_b32 v25, v29
    v_fma_f32 v105, v105, s20, -v121
    v_fma_f32 v107, v107, s20, -v121
    v_fma_f32 v109, v109, s20, -v121
    v_fma_f32 v111, v111, s20, -v121
    v_exp_f32 v105, v105
    v_exp_f32 v107, v107
    v_exp_f32 v109, v109
    v_exp_f32 v111, v111
    v_mul_f32 v27, v27, v31
    v_mul_f32 v16, v16, v31
    v_mul_f32 v17, v17, v31
    v_mul_f32 v18, v18, v31
    v_mul_f32 v19, v19, v31
    v_mul_f32 v20, v20, v31
    v_mul_f32 v21, v21, v31
    v_mul_f32 v22, v22, v31
    v_mul_f32 v23, v23, v31
    v_add_f32 v29, v105, v107
    v_add_f32 v27, v27, v29
    v_add_f32 v29, v109, v111
    v_add_f32 v27, v27, v29
    s_waitcnt vmcnt(8)
    v_lshlrev_b32 v112, 16, v48
    v_and_b32 v113, 0xffff0000, v48
    v_lshlrev_b32 v114, 16, v49
    v_and_b32 v115, 0xffff0000, v49
    v_lshlrev_b32 v116, 16, v50
    v_and_b32 v117, 0xffff0000, v50
    v_lshlrev_b32 v118, 16, v51
    v_and_b32 v119, 0xffff0000, v51
    v_fmac_f32 v8, v104, v112
    v_fmac_f32 v16, v105, v112
    v_fmac_f32 v9, v104, v113
    v_fmac_f32 v17, v105, v113
    v_fmac_f32 v10, v104, v114
    v_fmac_f32 v18, v105, v114
    v_fmac_f32 v11, v104, v115
    v_fmac_f32 v19, v105, v115
    v_fmac_f32 v12, v104, v116
    v_fmac_f32 v20, v105, v116
    v_fmac_f32 v13, v104, v117
    v_fmac_f32 v21, v105, v117
    v_fmac_f32 v14, v104, v118
    v_fmac_f32 v22, v105, v118
    v_fmac_f32 v15, v104, v119
    v_fmac_f32 v23, v105, v119
    v_lshlrev_b32 v112, 16, v52
    v_and_b32 v113, 0xffff0000, v52
    v_lshlrev_b32 v114, 16, v53
    v_and_b32 v115, 0xffff0000, v53
    v_lshlrev_b32 v116, 16, v54
    v_and_b32 v117, 0xffff0000, v54
    v_lshlrev_b32 v118, 16, v55
    v_and_b32 v119, 0xffff0000, v55
    v_fmac_f32 v8, v106, v112
    v_fmac_f32 v16, v107, v112
    v_fmac_f32 v9, v106, v113
    v_fmac_f32 v17, v107, v113
    v_fmac_f32 v10, v106, v114
    v_fmac_f32 v18, v107, v114
    v_fmac_f32 v11, v106, v115
    v_fmac_f32 v19, v107, v115
    v_fmac_f32 v12, v106, v116
    v_fmac_f32 v20, v107, v116
    v_fmac_f32 v13, v106, v117
    v_fmac_f32 v21, v107, v117
    v_fmac_f32 v14, v106, v118
    v_fmac_f32 v22, v107, v118
    v_fmac_f32 v15, v106, v119
    v_fmac_f32 v23, v107, v119
    v_lshlrev_b32 v112, 16, v56
    v_and_b32 v113, 0xffff0000, v56
    v_lshlrev_b32 v114, 16, v57
    v_and_b32 v115, 0xffff0000, v57
    v_lshlrev_b32 v116, 16, v58
    v_and_b32 v117, 0xffff0000, v58
    v_lshlrev_b32 v118, 16, v59
    v_and_b32 v119, 0xffff0000, v59
    v_fmac_f32 v8, v108, v112
    v_fmac_f32 v16, v109, v112
    v_fmac_f32 v9, v108, v113
    v_fmac_f32 v17, v109, v113
    v_fmac_f32 v10, v108, v114
    v_fmac_f32 v18, v109, v114
    v_fmac_f32 v11, v108, v115
    v_fmac_f32 v19, v109, v115
    v_fmac_f32 v12, v108, v116
    v_fmac_f32 v20, v109, v116
    v_fmac_f32 v13, v108, v117
    v_fmac_f32 v21, v109, v117
    v_fmac_f32 v14, v108, v118
    v_fmac_f32 v22, v109, v118
    v_fmac_f32 v15, v108, v119
    v_fmac_f32 v23, v109, v119
    v_lshlrev_b32 v112, 16, v60
    v_and_b32 v113, 0xffff0000, v60
    v_lshlrev_b32 v114, 16, v61
    v_and_b32 v115, 0xffff0000, v61
    v_lshlrev_b32 v116, 16, v62
    v_and_b32 v117, 0xffff0000, v62
    v_lshlrev_b32 v118, 16, v63
    v_and_b32 v119, 0xffff0000, v63
    v_fmac_f32 v8, v110, v112
    v_fmac_f32 v16, v111, v112
    v_fmac_f32 v9, v110, v113
    v_fmac_f32 v17, v111, v113
    v_fmac_f32 v10, v110, v114
    v_fmac_f32 v18, v111, v114
    v_fmac_f32 v11, v110, v115
    v_fmac_f32 v19, v111, v115
    v_fmac_f32 v12, v110, v116
    v_fmac_f32 v20, v111, v116
    v_fmac_f32 v13, v110, v117
    v_fmac_f32 v21, v111, v117
    v_fmac_f32 v14, v110, v118
    v_fmac_f32 v22, v111, v118
    v_fmac_f32 v15, v110, v119
    v_fmac_f32 v23, v111, v119
    s_waitcnt vmcnt(4)
    v_dot2_f32_bf16 v104, v64, v96, 0
    v_dot2_f32_bf16 v104, v65, v97, v104
    v_dot2_f32_bf16 v104, v66, v98, v104
    v_dot2_f32_bf16 v104, v67, v99, v104
    v_dot2_f32_bf16 v105, v64, v100, 0
    v_dot2_f32_bf16 v105, v65, v101, v105
    v_dot2_f32_bf16 v105, v66, v102, v105
    v_dot2_f32_bf16 v105, v67, v103, v105
    v_dot2_f32_bf16 v106, v68, v96, 0
    v_dot2_f32_bf16 v106, v69, v97, v106
    v_dot2_f32_bf16 v106, v70, v98, v106
    v_dot2_f32_bf16 v106, v71, v99, v106
    v_dot2_f32_bf16 v107, v68, v100, 0
    v_dot2_f32_bf16 v107, v69, v101, v107
    v_dot2_f32_bf16 v107, v70, v102, v107
    v_dot2_f32_bf16 v107, v71, v103, v107
    v_dot2_f32_bf16 v108, v72, v96, 0
    v_dot2_f32_bf16 v108, v73, v97, v108
    v_dot2_f32_bf16 v108, v74, v98, v108
    v_dot2_f32_bf16 v108, v75, v99, v108
    v_dot2_f32_bf16 v109, v72, v100, 0
    v_dot2_f32_bf16 v109, v73, v101, v109
    v_dot2_f32_bf16 v109, v74, v102, v109
    v_dot2_f32_bf16 v109, v75, v103, v109
    v_dot2_f32_bf16 v110, v76, v96, 0
    v_dot2_f32_bf16 v110, v77, v97, v110
    v_dot2_f32_bf16 v110, v78, v98, v110
    v_dot2_f32_bf16 v110, v79, v99, v110
    v_dot2_f32_bf16 v111, v76, v100, 0
    v_dot2_f32_bf16 v111, v77, v101, v111
    v_dot2_f32_bf16 v111, v78, v102, v111
    v_dot2_f32_bf16 v111, v79, v103, v111
    v_add_f32_dpp v104, v104, v104 quad_perm:[1,0,3,2] row_mask:0xf bank_mask:0xf
    v_add_f32_dpp v105, v105, v105 quad_perm:[1,0,3,2] row_mask:0xf bank_mask:0xf
    v_add_f32_dpp v106, v106, v106 quad_perm:[1,0,3,2] row_mask:0xf bank_mask:0xf
    v_add_f32_dpp v107, v107, v107 quad_perm:[1,0,3,2] row_mask:0xf bank_mask:0xf
    v_add_f32_dpp v108, v108, v108 quad_perm:[1,0,3,2] row_mask:0xf bank_mask:0xf
    v_add_f32_dpp v109, v109, v109 quad_perm:[1,0,3,2] row_mask:0xf bank_mask:0xf
    v_add_f32_dpp v110, v110, v110 quad_perm:[1,0,3,2] row_mask:0xf bank_mask:0xf
    v_add_f32_dpp v111, v111, v111 quad_perm:[1,0,3,2] row_mask:0xf bank_mask:0xf
    v_add_f32_dpp v104, v104, v104 quad_perm:[2,3,0,1] row_mask:0xf bank_mask:0xf
    v_add_f32_dpp v105, v105, v105 quad_perm:[2,3,0,1] row_mask:0xf bank_mask:0xf
    v_add_f32_dpp v106, v106, v106 quad_perm:[2,3,0,1] row_mask:0xf bank_mask:0xf
    v_add_f32_dpp v107, v107, v107 quad_perm:[2,3,0,1] row_mask:0xf bank_mask:0xf
    v_add_f32_dpp v108, v108, v108 quad_perm:[2,3,0,1] row_mask:0xf bank_mask:0xf
    v_add_f32_dpp v109, v109, v109 quad_perm:[2,3,0,1] row_mask:0xf bank_mask:0xf
    v_add_f32_dpp v110, v110, v110 quad_perm:[2,3,0,1] row_mask:0xf bank_mask:0xf
    v_add_f32_dpp v111, v111, v111 quad_perm:[2,3,0,1] row_mask:0xf bank_mask:0xf
    v_add_f32_dpp v104, v104, v104 row_ror:4 row_mask:0xf bank_mask:0xf
    v_add_f32_dpp v105, v105, v105 row_ror:4 row_mask:0xf bank_mask:0xf
    v_add_f32_dpp v106, v106, v106 row_ror:4 row_mask:0xf bank_mask:0xf
    v_add_f32_dpp v107, v107, v107 row_ror:4 row_mask:0xf bank_mask:0xf
    v_add_f32_dpp v108, v108, v108 row_ror:4 row_mask:0xf bank_mask:0xf
    v_add_f32_dpp v109, v109, v109 row_ror:4 row_mask:0xf bank_mask:0xf
    v_add_f32_dpp v110, v110, v110 row_ror:4 row_mask:0xf bank_mask:0xf
    v_add_f32_dpp v111, v111, v111 row_ror:4 row_mask:0xf bank_mask:0xf
    v_add_f32_dpp v104, v104, v104 row_ror:8 row_mask:0xf bank_mask:0xf
    v_add_f32_dpp v105, v105, v105 row_ror:8 row_mask:0xf bank_mask:0xf
    v_add_f32_dpp v106, v106, v106 row_ror:8 row_mask:0xf bank_mask:0xf
    v_add_f32_dpp v107, v107, v107 row_ror:8 row_mask:0xf bank_mask:0xf
    v_add_f32_dpp v108, v108, v108 row_ror:8 row_mask:0xf bank_mask:0xf
    v_add_f32_dpp v109, v109, v109 row_ror:8 row_mask:0xf bank_mask:0xf
    v_add_f32_dpp v110, v110, v110 row_ror:8 row_mask:0xf bank_mask:0xf
    v_add_f32_dpp v111, v111, v111 row_ror:8 row_mask:0xf bank_mask:0xf
    v_max3_f32 v28, v104, v106, v108
    v_max3_f32 v28, v28, v110, v24
    v_sub_f32 v30, v24, v28
    v_mul_f32 v30, s20, v30
    v_mul_f32 v120, s20, v28
    v_exp_f32 v30, v30
    v_mov_b32 v24, v28
    v_fma_f32 v104, v104, s20, -v120
    v_fma_f32 v106, v106, s20, -v120
    v_fma_f32 v108, v108, s20, -v120
    v_fma_f32 v110, v110, s20, -v120
    v_exp_f32 v104, v104
    v_exp_f32 v106, v106
    v_exp_f32 v108, v108
    v_exp_f32 v110, v110
    v_mul_f32 v26, v26, v30
    v_mul_f32 v8, v8, v30
    v_mul_f32 v9, v9, v30
    v_mul_f32 v10, v10, v30
    v_mul_f32 v11, v11, v30
    v_mul_f32 v12, v12, v30
    v_mul_f32 v13, v13, v30
    v_mul_f32 v14, v14, v30
    v_mul_f32 v15, v15, v30
    v_add_f32 v28, v104, v106
    v_add_f32 v26, v26, v28
    v_add_f32 v28, v108, v110
    v_add_f32 v26, v26, v28
    v_max3_f32 v29, v105, v107, v109
    v_max3_f32 v29, v29, v111, v25
    v_sub_f32 v31, v25, v29
    v_mul_f32 v31, s20, v31
    v_mul_f32 v121, s20, v29
    v_exp_f32 v31, v31
    v_mov_b32 v25, v29
    v_fma_f32 v105, v105, s20, -v121
    v_fma_f32 v107, v107, s20, -v121
    v_fma_f32 v109, v109, s20, -v121
    v_fma_f32 v111, v111, s20, -v121
    v_exp_f32 v105, v105
    v_exp_f32 v107, v107
    v_exp_f32 v109, v109
    v_exp_f32 v111, v111
    v_mul_f32 v27, v27, v31
    v_mul_f32 v16, v16, v31
    v_mul_f32 v17, v17, v31
    v_mul_f32 v18, v18, v31
    v_mul_f32 v19, v19, v31
    v_mul_f32 v20, v20, v31
    v_mul_f32 v21, v21, v31
    v_mul_f32 v22, v22, v31
    v_mul_f32 v23, v23, v31
    v_add_f32 v29, v105, v107
    v_add_f32 v27, v27, v29
    v_add_f32 v29, v109, v111
    v_add_f32 v27, v27, v29
    s_waitcnt vmcnt(0)
    v_lshlrev_b32 v112, 16, v80
    v_and_b32 v113, 0xffff0000, v80
    v_lshlrev_b32 v114, 16, v81
    v_and_b32 v115, 0xffff0000, v81
    v_lshlrev_b32 v116, 16, v82
    v_and_b32 v117, 0xffff0000, v82
    v_lshlrev_b32 v118, 16, v83
    v_and_b32 v119, 0xffff0000, v83
    v_fmac_f32 v8, v104, v112
    v_fmac_f32 v16, v105, v112
    v_fmac_f32 v9, v104, v113
    v_fmac_f32 v17, v105, v113
    v_fmac_f32 v10, v104, v114
    v_fmac_f32 v18, v105, v114
    v_fmac_f32 v11, v104, v115
    v_fmac_f32 v19, v105, v115
    v_fmac_f32 v12, v104, v116
    v_fmac_f32 v20, v105, v116
    v_fmac_f32 v13, v104, v117
    v_fmac_f32 v21, v105, v117
    v_fmac_f32 v14, v104, v118
    v_fmac_f32 v22, v105, v118
    v_fmac_f32 v15, v104, v119
    v_fmac_f32 v23, v105, v119
    v_lshlrev_b32 v112, 16, v84
    v_and_b32 v113, 0xffff0000, v84
    v_lshlrev_b32 v114, 16, v85
    v_and_b32 v115, 0xffff0000, v85
    v_lshlrev_b32 v116, 16, v86
    v_and_b32 v117, 0xffff0000, v86
    v_lshlrev_b32 v118, 16, v87
    v_and_b32 v119, 0xffff0000, v87
    v_fmac_f32 v8, v106, v112
    v_fmac_f32 v16, v107, v112
    v_fmac_f32 v9, v106, v113
    v_fmac_f32 v17, v107, v113
    v_fmac_f32 v10, v106, v114
    v_fmac_f32 v18, v107, v114
    v_fmac_f32 v11, v106, v115
    v_fmac_f32 v19, v107, v115
    v_fmac_f32 v12, v106, v116
    v_fmac_f32 v20, v107, v116
    v_fmac_f32 v13, v106, v117
    v_fmac_f32 v21, v107, v117
    v_fmac_f32 v14, v106, v118
    v_fmac_f32 v22, v107, v118
    v_fmac_f32 v15, v106, v119
    v_fmac_f32 v23, v107, v119
    v_lshlrev_b32 v112, 16, v88
    v_and_b32 v113, 0xffff0000, v88
    v_lshlrev_b32 v114, 16, v89
    v_and_b32 v115, 0xffff0000, v89
    v_lshlrev_b32 v116, 16, v90
    v_and_b32 v117, 0xffff0000, v90
    v_lshlrev_b32 v118, 16, v91
    v_and_b32 v119, 0xffff0000, v91
    v_fmac_f32 v8, v108, v112
    v_fmac_f32 v16, v109, v112
    v_fmac_f32 v9, v108, v113
    v_fmac_f32 v17, v109, v113
    v_fmac_f32 v10, v108, v114
    v_fmac_f32 v18, v109, v114
    v_fmac_f32 v11, v108, v115
    v_fmac_f32 v19, v109, v115
    v_fmac_f32 v12, v108, v116
    v_fmac_f32 v20, v109, v116
    v_fmac_f32 v13, v108, v117
    v_fmac_f32 v21, v109, v117
    v_fmac_f32 v14, v108, v118
    v_fmac_f32 v22, v109, v118
    v_fmac_f32 v15, v108, v119
    v_fmac_f32 v23, v109, v119
    v_lshlrev_b32 v112, 16, v92
    v_and_b32 v113, 0xffff0000, v92
    v_lshlrev_b32 v114, 16, v93
    v_and_b32 v115, 0xffff0000, v93
    v_lshlrev_b32 v116, 16, v94
    v_and_b32 v117, 0xffff0000, v94
    v_lshlrev_b32 v118, 16, v95
    v_and_b32 v119, 0xffff0000, v95
    v_fmac_f32 v8, v110, v112
    v_fmac_f32 v16, v111, v112
    v_fmac_f32 v9, v110, v113
    v_fmac_f32 v17, v111, v113
    v_fmac_f32 v10, v110, v114
    v_fmac_f32 v18, v111, v114
    v_fmac_f32 v11, v110, v115
    v_fmac_f32 v19, v111, v115
    v_fmac_f32 v12, v110, v116
    v_fmac_f32 v20, v111, v116
    v_fmac_f32 v13, v110, v117
    v_fmac_f32 v21, v111, v117
    v_fmac_f32 v14, v110, v118
    v_fmac_f32 v22, v111, v118
    v_fmac_f32 v15, v110, v119
    v_fmac_f32 v23, v111, v119
    v_lshrrev_b32 v4, 4, v0
    v_lshlrev_b32 v5, 9, v4
    v_and_b32 v6, 15, v0
    v_lshl_add_u32 v5, v6, 5, v5
    ds_write_b128 v5, v[8:11] offset:0
    ds_write_b128 v5, v[16:19] offset:16384
    ds_write_b128 v5, v[12:15] offset:16
    ds_write_b128 v5, v[20:23] offset:16400
    v_lshlrev_b32 v6, 3, v4
    v_mov_b32 v28, v24
    v_mov_b32 v29, v26
    ds_write_b64 v6, v[28:29] offset:32768
    v_mov_b32 v30, v25
    v_mov_b32 v31, v27
    ds_write_b64 v6, v[30:31] offset:33024
    s_waitcnt lgkmcnt(0)
    s_barrier
    s_cmp_ge_u32 s10, 4
    s_cbranch_scc1 La_end
    v_lshrrev_b32 v4, 7, v0
    v_and_b32 v5, 127, v0
    v_lshlrev_b32 v6, 8, v4
    v_lshlrev_b32 v7, 14, v4
    v_lshl_add_u32 v7, v5, 2, v7
    ds_read_b64 v[32:33], v6 offset:32768
    ds_read_b64 v[34:35], v6 offset:32776
    ds_read_b64 v[36:37], v6 offset:32784
    ds_read_b64 v[38:39], v6 offset:32792
    ds_read_b64 v[40:41], v6 offset:32800
    ds_read_b64 v[42:43], v6 offset:32808
    ds_read_b64 v[44:45], v6 offset:32816
    ds_read_b64 v[46:47], v6 offset:32824
    ds_read_b64 v[48:49], v6 offset:32832
    ds_read_b64 v[50:51], v6 offset:32840
    ds_read_b64 v[52:53], v6 offset:32848
    ds_read_b64 v[54:55], v6 offset:32856
    ds_read_b64 v[56:57], v6 offset:32864
    ds_read_b64 v[58:59], v6 offset:32872
    ds_read_b64 v[60:61], v6 offset:32880
    ds_read_b64 v[62:63], v6 offset:32888
    ds_read_b64 v[64:65], v6 offset:32896
    ds_read_b64 v[66:67], v6 offset:32904
    ds_read_b64 v[68:69], v6 offset:32912
    ds_read_b64 v[70:71], v6 offset:32920
    ds_read_b64 v[72:73], v6 offset:32928
    ds_read_b64 v[74:75], v6 offset:32936
    ds_read_b64 v[76:77], v6 offset:32944
    ds_read_b64 v[78:79], v6 offset:32952
    ds_read_b64 v[80:81], v6 offset:32960
    ds_read_b64 v[82:83], v6 offset:32968
    ds_read_b64 v[84:85], v6 offset:32976
    ds_read_b64 v[86:87], v6 offset:32984
    ds_read_b64 v[88:89], v6 offset:32992
    ds_read_b64 v[90:91], v6 offset:33000
    ds_read_b64 v[92:93], v6 offset:33008
    ds_read_b64 v[94:95], v6 offset:33016
    s_waitcnt lgkmcnt(0)
    v_max_f32 v8, v32, v34
    v_max_f32 v8, v8, v36
    v_max_f32 v8, v8, v38
    v_max_f32 v8, v8, v40
    v_max_f32 v8, v8, v42
    v_max_f32 v8, v8, v44
    v_max_f32 v8, v8, v46
    v_max_f32 v8, v8, v48
    v_max_f32 v8, v8, v50
    v_max_f32 v8, v8, v52
    v_max_f32 v8, v8, v54
    v_max_f32 v8, v8, v56
    v_max_f32 v8, v8, v58
    v_max_f32 v8, v8, v60
    v_max_f32 v8, v8, v62
    v_max_f32 v8, v8, v64
    v_max_f32 v8, v8, v66
    v_max_f32 v8, v8, v68
    v_max_f32 v8, v8, v70
    v_max_f32 v8, v8, v72
    v_max_f32 v8, v8, v74
    v_max_f32 v8, v8, v76
    v_max_f32 v8, v8, v78
    v_max_f32 v8, v8, v80
    v_max_f32 v8, v8, v82
    v_max_f32 v8, v8, v84
    v_max_f32 v8, v8, v86
    v_max_f32 v8, v8, v88
    v_max_f32 v8, v8, v90
    v_max_f32 v8, v8, v92
    v_max_f32 v8, v8, v94
    v_mul_f32 v9, s20, v8
    v_fma_f32 v32, v32, s20, -v9
    v_fma_f32 v34, v34, s20, -v9
    v_fma_f32 v36, v36, s20, -v9
    v_fma_f32 v38, v38, s20, -v9
    v_fma_f32 v40, v40, s20, -v9
    v_fma_f32 v42, v42, s20, -v9
    v_fma_f32 v44, v44, s20, -v9
    v_fma_f32 v46, v46, s20, -v9
    v_fma_f32 v48, v48, s20, -v9
    v_fma_f32 v50, v50, s20, -v9
    v_fma_f32 v52, v52, s20, -v9
    v_fma_f32 v54, v54, s20, -v9
    v_fma_f32 v56, v56, s20, -v9
    v_fma_f32 v58, v58, s20, -v9
    v_fma_f32 v60, v60, s20, -v9
    v_fma_f32 v62, v62, s20, -v9
    v_fma_f32 v64, v64, s20, -v9
    v_fma_f32 v66, v66, s20, -v9
    v_fma_f32 v68, v68, s20, -v9
    v_fma_f32 v70, v70, s20, -v9
    v_fma_f32 v72, v72, s20, -v9
    v_fma_f32 v74, v74, s20, -v9
    v_fma_f32 v76, v76, s20, -v9
    v_fma_f32 v78, v78, s20, -v9
    v_fma_f32 v80, v80, s20, -v9
    v_fma_f32 v82, v82, s20, -v9
    v_fma_f32 v84, v84, s20, -v9
    v_fma_f32 v86, v86, s20, -v9
    v_fma_f32 v88, v88, s20, -v9
    v_fma_f32 v90, v90, s20, -v9
    v_fma_f32 v92, v92, s20, -v9
    v_fma_f32 v94, v94, s20, -v9
    v_exp_f32 v32, v32
    v_exp_f32 v34, v34
    v_exp_f32 v36, v36
    v_exp_f32 v38, v38
    v_exp_f32 v40, v40
    v_exp_f32 v42, v42
    v_exp_f32 v44, v44
    v_exp_f32 v46, v46
    v_exp_f32 v48, v48
    v_exp_f32 v50, v50
    v_exp_f32 v52, v52
    v_exp_f32 v54, v54
    v_exp_f32 v56, v56
    v_exp_f32 v58, v58
    v_exp_f32 v60, v60
    v_exp_f32 v62, v62
    v_exp_f32 v64, v64
    v_exp_f32 v66, v66
    v_exp_f32 v68, v68
    v_exp_f32 v70, v70
    v_exp_f32 v72, v72
    v_exp_f32 v74, v74
    v_exp_f32 v76, v76
    v_exp_f32 v78, v78
    v_exp_f32 v80, v80
    v_exp_f32 v82, v82
    v_exp_f32 v84, v84
    v_exp_f32 v86, v86
    v_exp_f32 v88, v88
    v_exp_f32 v90, v90
    v_exp_f32 v92, v92
    v_exp_f32 v94, v94
    ds_read_b32 v96, v7 offset:0
    ds_read_b32 v97, v7 offset:512
    ds_read_b32 v98, v7 offset:1024
    ds_read_b32 v99, v7 offset:1536
    ds_read_b32 v100, v7 offset:2048
    ds_read_b32 v101, v7 offset:2560
    ds_read_b32 v102, v7 offset:3072
    ds_read_b32 v103, v7 offset:3584
    ds_read_b32 v104, v7 offset:4096
    ds_read_b32 v105, v7 offset:4608
    ds_read_b32 v106, v7 offset:5120
    ds_read_b32 v107, v7 offset:5632
    ds_read_b32 v108, v7 offset:6144
    ds_read_b32 v109, v7 offset:6656
    ds_read_b32 v110, v7 offset:7168
    ds_read_b32 v111, v7 offset:7680
    ds_read_b32 v112, v7 offset:8192
    ds_read_b32 v113, v7 offset:8704
    ds_read_b32 v114, v7 offset:9216
    ds_read_b32 v115, v7 offset:9728
    ds_read_b32 v116, v7 offset:10240
    ds_read_b32 v117, v7 offset:10752
    ds_read_b32 v118, v7 offset:11264
    ds_read_b32 v119, v7 offset:11776
    ds_read_b32 v120, v7 offset:12288
    ds_read_b32 v121, v7 offset:12800
    ds_read_b32 v122, v7 offset:13312
    ds_read_b32 v123, v7 offset:13824
    ds_read_b32 v124, v7 offset:14336
    ds_read_b32 v125, v7 offset:14848
    ds_read_b32 v126, v7 offset:15360
    ds_read_b32 v127, v7 offset:15872
    v_mov_b32 v10, 0
    v_mov_b32 v11, 0
    v_fmac_f32 v10, v32, v33
    v_fmac_f32 v10, v34, v35
    v_fmac_f32 v10, v36, v37
    v_fmac_f32 v10, v38, v39
    v_fmac_f32 v10, v40, v41
    v_fmac_f32 v10, v42, v43
    v_fmac_f32 v10, v44, v45
    v_fmac_f32 v10, v46, v47
    v_fmac_f32 v10, v48, v49
    v_fmac_f32 v10, v50, v51
    v_fmac_f32 v10, v52, v53
    v_fmac_f32 v10, v54, v55
    v_fmac_f32 v10, v56, v57
    v_fmac_f32 v10, v58, v59
    v_fmac_f32 v10, v60, v61
    v_fmac_f32 v10, v62, v63
    v_fmac_f32 v10, v64, v65
    v_fmac_f32 v10, v66, v67
    v_fmac_f32 v10, v68, v69
    v_fmac_f32 v10, v70, v71
    v_fmac_f32 v10, v72, v73
    v_fmac_f32 v10, v74, v75
    v_fmac_f32 v10, v76, v77
    v_fmac_f32 v10, v78, v79
    v_fmac_f32 v10, v80, v81
    v_fmac_f32 v10, v82, v83
    v_fmac_f32 v10, v84, v85
    v_fmac_f32 v10, v86, v87
    v_fmac_f32 v10, v88, v89
    v_fmac_f32 v10, v90, v91
    v_fmac_f32 v10, v92, v93
    v_fmac_f32 v10, v94, v95
    s_waitcnt lgkmcnt(0)
    v_fmac_f32 v11, v32, v96
    v_fmac_f32 v11, v34, v97
    v_fmac_f32 v11, v36, v98
    v_fmac_f32 v11, v38, v99
    v_fmac_f32 v11, v40, v100
    v_fmac_f32 v11, v42, v101
    v_fmac_f32 v11, v44, v102
    v_fmac_f32 v11, v46, v103
    v_fmac_f32 v11, v48, v104
    v_fmac_f32 v11, v50, v105
    v_fmac_f32 v11, v52, v106
    v_fmac_f32 v11, v54, v107
    v_fmac_f32 v11, v56, v108
    v_fmac_f32 v11, v58, v109
    v_fmac_f32 v11, v60, v110
    v_fmac_f32 v11, v62, v111
    v_fmac_f32 v11, v64, v112
    v_fmac_f32 v11, v66, v113
    v_fmac_f32 v11, v68, v114
    v_fmac_f32 v11, v70, v115
    v_fmac_f32 v11, v72, v116
    v_fmac_f32 v11, v74, v117
    v_fmac_f32 v11, v76, v118
    v_fmac_f32 v11, v78, v119
    v_fmac_f32 v11, v80, v120
    v_fmac_f32 v11, v82, v121
    v_fmac_f32 v11, v84, v122
    v_fmac_f32 v11, v86, v123
    v_fmac_f32 v11, v88, v124
    v_fmac_f32 v11, v90, v125
    v_fmac_f32 v11, v92, v126
    v_fmac_f32 v11, v94, v127
    s_lshl_b32 s24, s2, 10
    s_add_u32 s24, s24, 131072
    v_lshlrev_b32 v12, 2, v0
    v_add_u32 v12, s24, v12
    global_store_dword v12, v11, s[8:9]
    s_lshl_b32 s24, s2, 4
    s_add_u32 s24, s24, 393216
    v_lshlrev_b32 v12, 3, v4
    v_add_u32 v12, s24, v12
    v_mov_b32 v14, v8
    v_mov_b32 v15, v10
    v_cmp_eq_u32 vcc, 0, v5
    s_nop 0
    s_and_saveexec_b64 s[26:27], vcc
    global_store_dwordx2 v12, v[14:15], s[8:9]
    s_mov_b64 exec, s[26:27]
    s_branch La_end
Lffn:
    s_load_dwordx2 s[4:5], s[0:1], 0
    s_load_dwordx2 s[6:7], s[0:1], 48
    s_load_dwordx2 s[10:11], s[0:1], 56
    s_load_dwordx2 s[12:13], s[0:1], 64
    s_sub_u32 s14, s2, 256
    v_and_b32 v1, 63, v0
    v_lshrrev_b32 v2, 6, v0
    v_lshrrev_b32 v3, 3, v1
    v_and_b32 v4, 7, v1
    v_mul_u32_u24 v5, 72, v2
    v_add_u32 v5, v5, v3
    v_mul_u32_u24 v6, 9216, v5
    v_lshl_add_u32 v6, v4, 4, v6
    s_lshl_b32 s15, s14, 7
    v_add_u32 v6, s15, v6
    v_lshlrev_b32 v7, 1, v5
    s_mov_b32 s21, 0x40135761
    s_mov_b32 s22, 0x3d372713
    s_waitcnt lgkmcnt(0)
    v_mov_b32 v88, 0
    v_mov_b32 v89, 0
    v_mov_b32 v90, 0
    v_mov_b32 v91, 0
    v_mov_b32 v92, 0
    v_mov_b32 v93, 0
    v_mov_b32 v94, 0
    v_mov_b32 v95, 0
    v_mov_b32 v96, 0
    v_mov_b32 v97, 0
    v_mov_b32 v98, 0
    v_mov_b32 v99, 0
    v_mov_b32 v100, 0
    v_mov_b32 v101, 0
    v_mov_b32 v102, 0
    v_mov_b32 v103, 0
    v_mov_b32 v104, 0
    v_mov_b32 v105, 0
    v_mov_b32 v106, 0
    v_mov_b32 v107, 0
    v_mov_b32 v108, 0
    v_mov_b32 v109, 0
    v_mov_b32 v110, 0
    v_mov_b32 v111, 0
    v_mov_b32 v112, 0
    v_mov_b32 v113, 0
    v_mov_b32 v114, 0
    v_mov_b32 v115, 0
    v_mov_b32 v116, 0
    v_mov_b32 v117, 0
    v_mov_b32 v118, 0
    v_mov_b32 v119, 0
    v_mov_b32 v8, v6
    global_load_dwordx4 v[32:35], v8, s[6:7]
    v_add_u32 v8, 73728, v8
    global_load_ushort v68, v7, s[4:5] offset:0
    global_load_ushort v69, v7, s[4:5] offset:1152
    global_load_dwordx4 v[36:39], v8, s[6:7]
    v_add_u32 v8, 73728, v8
    global_load_ushort v70, v7, s[4:5] offset:16
    global_load_ushort v71, v7, s[4:5] offset:1168
    global_load_dwordx4 v[40:43], v8, s[6:7]
    v_add_u32 v8, 73728, v8
    global_load_ushort v72, v7, s[4:5] offset:32
    global_load_ushort v73, v7, s[4:5] offset:1184
    global_load_dwordx4 v[44:47], v8, s[6:7]
    v_add_u32 v8, 73728, v8
    global_load_ushort v74, v7, s[4:5] offset:48
    global_load_ushort v75, v7, s[4:5] offset:1200
    global_load_dwordx4 v[48:51], v8, s[6:7]
    v_add_u32 v8, 73728, v8
    global_load_ushort v76, v7, s[4:5] offset:64
    global_load_ushort v77, v7, s[4:5] offset:1216
    global_load_dwordx4 v[52:55], v8, s[6:7]
    v_add_u32 v8, 73728, v8
    global_load_ushort v78, v7, s[4:5] offset:80
    global_load_ushort v79, v7, s[4:5] offset:1232
    global_load_dwordx4 v[56:59], v8, s[6:7]
    v_add_u32 v8, 73728, v8
    global_load_ushort v80, v7, s[4:5] offset:96
    global_load_ushort v81, v7, s[4:5] offset:1248
    global_load_dwordx4 v[60:63], v8, s[6:7]
    v_add_u32 v8, 73728, v8
    global_load_ushort v82, v7, s[4:5] offset:112
    global_load_ushort v83, v7, s[4:5] offset:1264
    global_load_dwordx4 v[64:67], v8, s[6:7]
    v_add_u32 v8, 73728, v8
    global_load_ushort v84, v7, s[4:5] offset:128
    global_load_ushort v85, v7, s[4:5] offset:1280
    s_waitcnt vmcnt(24)
    v_lshlrev_b32 v68, 16, v68
    v_lshlrev_b32 v69, 16, v69
    v_lshlrev_b32 v120, 16, v32
    v_and_b32 v121, 0xffff0000, v32
    v_lshlrev_b32 v122, 16, v33
    v_and_b32 v123, 0xffff0000, v33
    v_lshlrev_b32 v124, 16, v34
    v_and_b32 v125, 0xffff0000, v34
    v_lshlrev_b32 v126, 16, v35
    v_and_b32 v127, 0xffff0000, v35
    v_fmac_f32 v88, v68, v120
    v_fmac_f32 v89, v68, v121
    v_fmac_f32 v90, v68, v122
    v_fmac_f32 v91, v68, v123
    v_fmac_f32 v92, v68, v124
    v_fmac_f32 v93, v68, v125
    v_fmac_f32 v94, v68, v126
    v_fmac_f32 v95, v68, v127
    v_fmac_f32 v96, v69, v120
    v_fmac_f32 v97, v69, v121
    v_fmac_f32 v98, v69, v122
    v_fmac_f32 v99, v69, v123
    v_fmac_f32 v100, v69, v124
    v_fmac_f32 v101, v69, v125
    v_fmac_f32 v102, v69, v126
    v_fmac_f32 v103, v69, v127
    s_waitcnt vmcnt(21)
    v_lshlrev_b32 v70, 16, v70
    v_lshlrev_b32 v71, 16, v71
    v_lshlrev_b32 v120, 16, v36
    v_and_b32 v121, 0xffff0000, v36
    v_lshlrev_b32 v122, 16, v37
    v_and_b32 v123, 0xffff0000, v37
    v_lshlrev_b32 v124, 16, v38
    v_and_b32 v125, 0xffff0000, v38
    v_lshlrev_b32 v126, 16, v39
    v_and_b32 v127, 0xffff0000, v39
    v_fmac_f32 v88, v70, v120
    v_fmac_f32 v89, v70, v121
    v_fmac_f32 v90, v70, v122
    v_fmac_f32 v91, v70, v123
    v_fmac_f32 v92, v70, v124
    v_fmac_f32 v93, v70, v125
    v_fmac_f32 v94, v70, v126
    v_fmac_f32 v95, v70, v127
    v_fmac_f32 v96, v71, v120
    v_fmac_f32 v97, v71, v121
    v_fmac_f32 v98, v71, v122
    v_fmac_f32 v99, v71, v123
    v_fmac_f32 v100, v71, v124
    v_fmac_f32 v101, v71, v125
    v_fmac_f32 v102, v71, v126
    v_fmac_f32 v103, v71, v127
    s_waitcnt vmcnt(18)
    v_lshlrev_b32 v72, 16, v72
    v_lshlrev_b32 v73, 16, v73
    v_lshlrev_b32 v120, 16, v40
    v_and_b32 v121, 0xffff0000, v40
    v_lshlrev_b32 v122, 16, v41
    v_and_b32 v123, 0xffff0000, v41
    v_lshlrev_b32 v124, 16, v42
    v_and_b32 v125, 0xffff0000, v42
    v_lshlrev_b32 v126, 16, v43
    v_and_b32 v127, 0xffff0000, v43
    v_fmac_f32 v88, v72, v120
    v_fmac_f32 v89, v72, v121
    v_fmac_f32 v90, v72, v122
    v_fmac_f32 v91, v72, v123
    v_fmac_f32 v92, v72, v124
    v_fmac_f32 v93, v72, v125
    v_fmac_f32 v94, v72, v126
    v_fmac_f32 v95, v72, v127
    v_fmac_f32 v96, v73, v120
    v_fmac_f32 v97, v73, v121
    v_fmac_f32 v98, v73, v122
    v_fmac_f32 v99, v73, v123
    v_fmac_f32 v100, v73, v124
    v_fmac_f32 v101, v73, v125
    v_fmac_f32 v102, v73, v126
    v_fmac_f32 v103, v73, v127
    s_waitcnt vmcnt(15)
    v_lshlrev_b32 v74, 16, v74
    v_lshlrev_b32 v75, 16, v75
    v_lshlrev_b32 v120, 16, v44
    v_and_b32 v121, 0xffff0000, v44
    v_lshlrev_b32 v122, 16, v45
    v_and_b32 v123, 0xffff0000, v45
    v_lshlrev_b32 v124, 16, v46
    v_and_b32 v125, 0xffff0000, v46
    v_lshlrev_b32 v126, 16, v47
    v_and_b32 v127, 0xffff0000, v47
    v_fmac_f32 v88, v74, v120
    v_fmac_f32 v89, v74, v121
    v_fmac_f32 v90, v74, v122
    v_fmac_f32 v91, v74, v123
    v_fmac_f32 v92, v74, v124
    v_fmac_f32 v93, v74, v125
    v_fmac_f32 v94, v74, v126
    v_fmac_f32 v95, v74, v127
    v_fmac_f32 v96, v75, v120
    v_fmac_f32 v97, v75, v121
    v_fmac_f32 v98, v75, v122
    v_fmac_f32 v99, v75, v123
    v_fmac_f32 v100, v75, v124
    v_fmac_f32 v101, v75, v125
    v_fmac_f32 v102, v75, v126
    v_fmac_f32 v103, v75, v127
    s_waitcnt vmcnt(12)
    v_lshlrev_b32 v76, 16, v76
    v_lshlrev_b32 v77, 16, v77
    v_lshlrev_b32 v120, 16, v48
    v_and_b32 v121, 0xffff0000, v48
    v_lshlrev_b32 v122, 16, v49
    v_and_b32 v123, 0xffff0000, v49
    v_lshlrev_b32 v124, 16, v50
    v_and_b32 v125, 0xffff0000, v50
    v_lshlrev_b32 v126, 16, v51
    v_and_b32 v127, 0xffff0000, v51
    v_fmac_f32 v88, v76, v120
    v_fmac_f32 v89, v76, v121
    v_fmac_f32 v90, v76, v122
    v_fmac_f32 v91, v76, v123
    v_fmac_f32 v92, v76, v124
    v_fmac_f32 v93, v76, v125
    v_fmac_f32 v94, v76, v126
    v_fmac_f32 v95, v76, v127
    v_fmac_f32 v96, v77, v120
    v_fmac_f32 v97, v77, v121
    v_fmac_f32 v98, v77, v122
    v_fmac_f32 v99, v77, v123
    v_fmac_f32 v100, v77, v124
    v_fmac_f32 v101, v77, v125
    v_fmac_f32 v102, v77, v126
    v_fmac_f32 v103, v77, v127
    s_waitcnt vmcnt(9)
    v_lshlrev_b32 v78, 16, v78
    v_lshlrev_b32 v79, 16, v79
    v_lshlrev_b32 v120, 16, v52
    v_and_b32 v121, 0xffff0000, v52
    v_lshlrev_b32 v122, 16, v53
    v_and_b32 v123, 0xffff0000, v53
    v_lshlrev_b32 v124, 16, v54
    v_and_b32 v125, 0xffff0000, v54
    v_lshlrev_b32 v126, 16, v55
    v_and_b32 v127, 0xffff0000, v55
    v_fmac_f32 v88, v78, v120
    v_fmac_f32 v89, v78, v121
    v_fmac_f32 v90, v78, v122
    v_fmac_f32 v91, v78, v123
    v_fmac_f32 v92, v78, v124
    v_fmac_f32 v93, v78, v125
    v_fmac_f32 v94, v78, v126
    v_fmac_f32 v95, v78, v127
    v_fmac_f32 v96, v79, v120
    v_fmac_f32 v97, v79, v121
    v_fmac_f32 v98, v79, v122
    v_fmac_f32 v99, v79, v123
    v_fmac_f32 v100, v79, v124
    v_fmac_f32 v101, v79, v125
    v_fmac_f32 v102, v79, v126
    v_fmac_f32 v103, v79, v127
    s_waitcnt vmcnt(6)
    v_lshlrev_b32 v80, 16, v80
    v_lshlrev_b32 v81, 16, v81
    v_lshlrev_b32 v120, 16, v56
    v_and_b32 v121, 0xffff0000, v56
    v_lshlrev_b32 v122, 16, v57
    v_and_b32 v123, 0xffff0000, v57
    v_lshlrev_b32 v124, 16, v58
    v_and_b32 v125, 0xffff0000, v58
    v_lshlrev_b32 v126, 16, v59
    v_and_b32 v127, 0xffff0000, v59
    v_fmac_f32 v88, v80, v120
    v_fmac_f32 v89, v80, v121
    v_fmac_f32 v90, v80, v122
    v_fmac_f32 v91, v80, v123
    v_fmac_f32 v92, v80, v124
    v_fmac_f32 v93, v80, v125
    v_fmac_f32 v94, v80, v126
    v_fmac_f32 v95, v80, v127
    v_fmac_f32 v96, v81, v120
    v_fmac_f32 v97, v81, v121
    v_fmac_f32 v98, v81, v122
    v_fmac_f32 v99, v81, v123
    v_fmac_f32 v100, v81, v124
    v_fmac_f32 v101, v81, v125
    v_fmac_f32 v102, v81, v126
    v_fmac_f32 v103, v81, v127
    s_waitcnt vmcnt(3)
    v_lshlrev_b32 v82, 16, v82
    v_lshlrev_b32 v83, 16, v83
    v_lshlrev_b32 v120, 16, v60
    v_and_b32 v121, 0xffff0000, v60
    v_lshlrev_b32 v122, 16, v61
    v_and_b32 v123, 0xffff0000, v61
    v_lshlrev_b32 v124, 16, v62
    v_and_b32 v125, 0xffff0000, v62
    v_lshlrev_b32 v126, 16, v63
    v_and_b32 v127, 0xffff0000, v63
    v_fmac_f32 v88, v82, v120
    v_fmac_f32 v89, v82, v121
    v_fmac_f32 v90, v82, v122
    v_fmac_f32 v91, v82, v123
    v_fmac_f32 v92, v82, v124
    v_fmac_f32 v93, v82, v125
    v_fmac_f32 v94, v82, v126
    v_fmac_f32 v95, v82, v127
    v_fmac_f32 v96, v83, v120
    v_fmac_f32 v97, v83, v121
    v_fmac_f32 v98, v83, v122
    v_fmac_f32 v99, v83, v123
    v_fmac_f32 v100, v83, v124
    v_fmac_f32 v101, v83, v125
    v_fmac_f32 v102, v83, v126
    v_fmac_f32 v103, v83, v127
    s_waitcnt vmcnt(0)
    v_lshlrev_b32 v84, 16, v84
    v_lshlrev_b32 v85, 16, v85
    v_lshlrev_b32 v120, 16, v64
    v_and_b32 v121, 0xffff0000, v64
    v_lshlrev_b32 v122, 16, v65
    v_and_b32 v123, 0xffff0000, v65
    v_lshlrev_b32 v124, 16, v66
    v_and_b32 v125, 0xffff0000, v66
    v_lshlrev_b32 v126, 16, v67
    v_and_b32 v127, 0xffff0000, v67
    v_fmac_f32 v88, v84, v120
    v_fmac_f32 v89, v84, v121
    v_fmac_f32 v90, v84, v122
    v_fmac_f32 v91, v84, v123
    v_fmac_f32 v92, v84, v124
    v_fmac_f32 v93, v84, v125
    v_fmac_f32 v94, v84, v126
    v_fmac_f32 v95, v84, v127
    v_fmac_f32 v96, v85, v120
    v_fmac_f32 v97, v85, v121
    v_fmac_f32 v98, v85, v122
    v_fmac_f32 v99, v85, v123
    v_fmac_f32 v100, v85, v124
    v_fmac_f32 v101, v85, v125
    v_fmac_f32 v102, v85, v126
    v_fmac_f32 v103, v85, v127
    v_mov_b32 v8, v6
    global_load_dwordx4 v[32:35], v8, s[10:11]
    v_add_u32 v8, 73728, v8
    global_load_dwordx4 v[36:39], v8, s[10:11]
    v_add_u32 v8, 73728, v8
    global_load_dwordx4 v[40:43], v8, s[10:11]
    v_add_u32 v8, 73728, v8
    global_load_dwordx4 v[44:47], v8, s[10:11]
    v_add_u32 v8, 73728, v8
    global_load_dwordx4 v[48:51], v8, s[10:11]
    v_add_u32 v8, 73728, v8
    global_load_dwordx4 v[52:55], v8, s[10:11]
    v_add_u32 v8, 73728, v8
    global_load_dwordx4 v[56:59], v8, s[10:11]
    v_add_u32 v8, 73728, v8
    global_load_dwordx4 v[60:63], v8, s[10:11]
    v_add_u32 v8, 73728, v8
    global_load_dwordx4 v[64:67], v8, s[10:11]
    v_add_u32 v8, 73728, v8
    s_waitcnt vmcnt(8)
    v_lshlrev_b32 v120, 16, v32
    v_and_b32 v121, 0xffff0000, v32
    v_lshlrev_b32 v122, 16, v33
    v_and_b32 v123, 0xffff0000, v33
    v_lshlrev_b32 v124, 16, v34
    v_and_b32 v125, 0xffff0000, v34
    v_lshlrev_b32 v126, 16, v35
    v_and_b32 v127, 0xffff0000, v35
    v_fmac_f32 v104, v68, v120
    v_fmac_f32 v105, v68, v121
    v_fmac_f32 v106, v68, v122
    v_fmac_f32 v107, v68, v123
    v_fmac_f32 v108, v68, v124
    v_fmac_f32 v109, v68, v125
    v_fmac_f32 v110, v68, v126
    v_fmac_f32 v111, v68, v127
    v_fmac_f32 v112, v69, v120
    v_fmac_f32 v113, v69, v121
    v_fmac_f32 v114, v69, v122
    v_fmac_f32 v115, v69, v123
    v_fmac_f32 v116, v69, v124
    v_fmac_f32 v117, v69, v125
    v_fmac_f32 v118, v69, v126
    v_fmac_f32 v119, v69, v127
    s_waitcnt vmcnt(7)
    v_lshlrev_b32 v120, 16, v36
    v_and_b32 v121, 0xffff0000, v36
    v_lshlrev_b32 v122, 16, v37
    v_and_b32 v123, 0xffff0000, v37
    v_lshlrev_b32 v124, 16, v38
    v_and_b32 v125, 0xffff0000, v38
    v_lshlrev_b32 v126, 16, v39
    v_and_b32 v127, 0xffff0000, v39
    v_fmac_f32 v104, v70, v120
    v_fmac_f32 v105, v70, v121
    v_fmac_f32 v106, v70, v122
    v_fmac_f32 v107, v70, v123
    v_fmac_f32 v108, v70, v124
    v_fmac_f32 v109, v70, v125
    v_fmac_f32 v110, v70, v126
    v_fmac_f32 v111, v70, v127
    v_fmac_f32 v112, v71, v120
    v_fmac_f32 v113, v71, v121
    v_fmac_f32 v114, v71, v122
    v_fmac_f32 v115, v71, v123
    v_fmac_f32 v116, v71, v124
    v_fmac_f32 v117, v71, v125
    v_fmac_f32 v118, v71, v126
    v_fmac_f32 v119, v71, v127
    s_waitcnt vmcnt(6)
    v_lshlrev_b32 v120, 16, v40
    v_and_b32 v121, 0xffff0000, v40
    v_lshlrev_b32 v122, 16, v41
    v_and_b32 v123, 0xffff0000, v41
    v_lshlrev_b32 v124, 16, v42
    v_and_b32 v125, 0xffff0000, v42
    v_lshlrev_b32 v126, 16, v43
    v_and_b32 v127, 0xffff0000, v43
    v_fmac_f32 v104, v72, v120
    v_fmac_f32 v105, v72, v121
    v_fmac_f32 v106, v72, v122
    v_fmac_f32 v107, v72, v123
    v_fmac_f32 v108, v72, v124
    v_fmac_f32 v109, v72, v125
    v_fmac_f32 v110, v72, v126
    v_fmac_f32 v111, v72, v127
    v_fmac_f32 v112, v73, v120
    v_fmac_f32 v113, v73, v121
    v_fmac_f32 v114, v73, v122
    v_fmac_f32 v115, v73, v123
    v_fmac_f32 v116, v73, v124
    v_fmac_f32 v117, v73, v125
    v_fmac_f32 v118, v73, v126
    v_fmac_f32 v119, v73, v127
    s_waitcnt vmcnt(5)
    v_lshlrev_b32 v120, 16, v44
    v_and_b32 v121, 0xffff0000, v44
    v_lshlrev_b32 v122, 16, v45
    v_and_b32 v123, 0xffff0000, v45
    v_lshlrev_b32 v124, 16, v46
    v_and_b32 v125, 0xffff0000, v46
    v_lshlrev_b32 v126, 16, v47
    v_and_b32 v127, 0xffff0000, v47
    v_fmac_f32 v104, v74, v120
    v_fmac_f32 v105, v74, v121
    v_fmac_f32 v106, v74, v122
    v_fmac_f32 v107, v74, v123
    v_fmac_f32 v108, v74, v124
    v_fmac_f32 v109, v74, v125
    v_fmac_f32 v110, v74, v126
    v_fmac_f32 v111, v74, v127
    v_fmac_f32 v112, v75, v120
    v_fmac_f32 v113, v75, v121
    v_fmac_f32 v114, v75, v122
    v_fmac_f32 v115, v75, v123
    v_fmac_f32 v116, v75, v124
    v_fmac_f32 v117, v75, v125
    v_fmac_f32 v118, v75, v126
    v_fmac_f32 v119, v75, v127
    s_waitcnt vmcnt(4)
    v_lshlrev_b32 v120, 16, v48
    v_and_b32 v121, 0xffff0000, v48
    v_lshlrev_b32 v122, 16, v49
    v_and_b32 v123, 0xffff0000, v49
    v_lshlrev_b32 v124, 16, v50
    v_and_b32 v125, 0xffff0000, v50
    v_lshlrev_b32 v126, 16, v51
    v_and_b32 v127, 0xffff0000, v51
    v_fmac_f32 v104, v76, v120
    v_fmac_f32 v105, v76, v121
    v_fmac_f32 v106, v76, v122
    v_fmac_f32 v107, v76, v123
    v_fmac_f32 v108, v76, v124
    v_fmac_f32 v109, v76, v125
    v_fmac_f32 v110, v76, v126
    v_fmac_f32 v111, v76, v127
    v_fmac_f32 v112, v77, v120
    v_fmac_f32 v113, v77, v121
    v_fmac_f32 v114, v77, v122
    v_fmac_f32 v115, v77, v123
    v_fmac_f32 v116, v77, v124
    v_fmac_f32 v117, v77, v125
    v_fmac_f32 v118, v77, v126
    v_fmac_f32 v119, v77, v127
    s_waitcnt vmcnt(3)
    v_lshlrev_b32 v120, 16, v52
    v_and_b32 v121, 0xffff0000, v52
    v_lshlrev_b32 v122, 16, v53
    v_and_b32 v123, 0xffff0000, v53
    v_lshlrev_b32 v124, 16, v54
    v_and_b32 v125, 0xffff0000, v54
    v_lshlrev_b32 v126, 16, v55
    v_and_b32 v127, 0xffff0000, v55
    v_fmac_f32 v104, v78, v120
    v_fmac_f32 v105, v78, v121
    v_fmac_f32 v106, v78, v122
    v_fmac_f32 v107, v78, v123
    v_fmac_f32 v108, v78, v124
    v_fmac_f32 v109, v78, v125
    v_fmac_f32 v110, v78, v126
    v_fmac_f32 v111, v78, v127
    v_fmac_f32 v112, v79, v120
    v_fmac_f32 v113, v79, v121
    v_fmac_f32 v114, v79, v122
    v_fmac_f32 v115, v79, v123
    v_fmac_f32 v116, v79, v124
    v_fmac_f32 v117, v79, v125
    v_fmac_f32 v118, v79, v126
    v_fmac_f32 v119, v79, v127
    s_waitcnt vmcnt(2)
    v_lshlrev_b32 v120, 16, v56
    v_and_b32 v121, 0xffff0000, v56
    v_lshlrev_b32 v122, 16, v57
    v_and_b32 v123, 0xffff0000, v57
    v_lshlrev_b32 v124, 16, v58
    v_and_b32 v125, 0xffff0000, v58
    v_lshlrev_b32 v126, 16, v59
    v_and_b32 v127, 0xffff0000, v59
    v_fmac_f32 v104, v80, v120
    v_fmac_f32 v105, v80, v121
    v_fmac_f32 v106, v80, v122
    v_fmac_f32 v107, v80, v123
    v_fmac_f32 v108, v80, v124
    v_fmac_f32 v109, v80, v125
    v_fmac_f32 v110, v80, v126
    v_fmac_f32 v111, v80, v127
    v_fmac_f32 v112, v81, v120
    v_fmac_f32 v113, v81, v121
    v_fmac_f32 v114, v81, v122
    v_fmac_f32 v115, v81, v123
    v_fmac_f32 v116, v81, v124
    v_fmac_f32 v117, v81, v125
    v_fmac_f32 v118, v81, v126
    v_fmac_f32 v119, v81, v127
    s_waitcnt vmcnt(1)
    v_lshlrev_b32 v120, 16, v60
    v_and_b32 v121, 0xffff0000, v60
    v_lshlrev_b32 v122, 16, v61
    v_and_b32 v123, 0xffff0000, v61
    v_lshlrev_b32 v124, 16, v62
    v_and_b32 v125, 0xffff0000, v62
    v_lshlrev_b32 v126, 16, v63
    v_and_b32 v127, 0xffff0000, v63
    v_fmac_f32 v104, v82, v120
    v_fmac_f32 v105, v82, v121
    v_fmac_f32 v106, v82, v122
    v_fmac_f32 v107, v82, v123
    v_fmac_f32 v108, v82, v124
    v_fmac_f32 v109, v82, v125
    v_fmac_f32 v110, v82, v126
    v_fmac_f32 v111, v82, v127
    v_fmac_f32 v112, v83, v120
    v_fmac_f32 v113, v83, v121
    v_fmac_f32 v114, v83, v122
    v_fmac_f32 v115, v83, v123
    v_fmac_f32 v116, v83, v124
    v_fmac_f32 v117, v83, v125
    v_fmac_f32 v118, v83, v126
    v_fmac_f32 v119, v83, v127
    s_waitcnt vmcnt(0)
    v_lshlrev_b32 v120, 16, v64
    v_and_b32 v121, 0xffff0000, v64
    v_lshlrev_b32 v122, 16, v65
    v_and_b32 v123, 0xffff0000, v65
    v_lshlrev_b32 v124, 16, v66
    v_and_b32 v125, 0xffff0000, v66
    v_lshlrev_b32 v126, 16, v67
    v_and_b32 v127, 0xffff0000, v67
    v_fmac_f32 v104, v84, v120
    v_fmac_f32 v105, v84, v121
    v_fmac_f32 v106, v84, v122
    v_fmac_f32 v107, v84, v123
    v_fmac_f32 v108, v84, v124
    v_fmac_f32 v109, v84, v125
    v_fmac_f32 v110, v84, v126
    v_fmac_f32 v111, v84, v127
    v_fmac_f32 v112, v85, v120
    v_fmac_f32 v113, v85, v121
    v_fmac_f32 v114, v85, v122
    v_fmac_f32 v115, v85, v123
    v_fmac_f32 v116, v85, v124
    v_fmac_f32 v117, v85, v125
    v_fmac_f32 v118, v85, v126
    v_fmac_f32 v119, v85, v127
    v_lshlrev_b32 v8, 7, v0
    ds_write_b128 v8, v[88:91] offset:0
    ds_write_b128 v8, v[92:95] offset:16
    ds_write_b128 v8, v[96:99] offset:32
    ds_write_b128 v8, v[100:103] offset:48
    ds_write_b128 v8, v[104:107] offset:64
    ds_write_b128 v8, v[108:111] offset:80
    ds_write_b128 v8, v[112:115] offset:96
    ds_write_b128 v8, v[116:119] offset:112
    s_waitcnt lgkmcnt(0)
    s_barrier
    v_readfirstlane_b32 s16, v2
    s_cmp_ge_u32 s16, 4
    s_cbranch_scc1 Lffn_b1
    v_lshrrev_b32 v9, 6, v0
    v_and_b32 v10, 63, v0
    v_lshrrev_b32 v11, 3, v10
    v_and_b32 v12, 7, v10
    v_lshlrev_b32 v11, 7, v11
    v_lshl_add_u32 v11, v9, 5, v11
    v_lshl_add_u32 v11, v12, 2, v11
    v_mov_b32 v13, 0
    ds_read_b32 v32, v11 offset:0
    ds_read_b32 v33, v11 offset:1024
    ds_read_b32 v34, v11 offset:2048
    ds_read_b32 v35, v11 offset:3072
    ds_read_b32 v36, v11 offset:4096
    ds_read_b32 v37, v11 offset:5120
    ds_read_b32 v38, v11 offset:6144
    ds_read_b32 v39, v11 offset:7168
    ds_read_b32 v40, v11 offset:8192
    ds_read_b32 v41, v11 offset:9216
    ds_read_b32 v42, v11 offset:10240
    ds_read_b32 v43, v11 offset:11264
    ds_read_b32 v44, v11 offset:12288
    ds_read_b32 v45, v11 offset:13312
    ds_read_b32 v46, v11 offset:14336
    ds_read_b32 v47, v11 offset:15360
    ds_read_b32 v48, v11 offset:16384
    ds_read_b32 v49, v11 offset:17408
    ds_read_b32 v50, v11 offset:18432
    ds_read_b32 v51, v11 offset:19456
    ds_read_b32 v52, v11 offset:20480
    ds_read_b32 v53, v11 offset:21504
    ds_read_b32 v54, v11 offset:22528
    ds_read_b32 v55, v11 offset:23552
    ds_read_b32 v56, v11 offset:24576
    ds_read_b32 v57, v11 offset:25600
    ds_read_b32 v58, v11 offset:26624
    ds_read_b32 v59, v11 offset:27648
    ds_read_b32 v60, v11 offset:28672
    ds_read_b32 v61, v11 offset:29696
    ds_read_b32 v62, v11 offset:30720
    ds_read_b32 v63, v11 offset:31744
    s_waitcnt lgkmcnt(0)
    v_add_f32 v13, v13, v32
    v_add_f32 v13, v13, v33
    v_add_f32 v13, v13, v34
    v_add_f32 v13, v13, v35
    v_add_f32 v13, v13, v36
    v_add_f32 v13, v13, v37
    v_add_f32 v13, v13, v38
    v_add_f32 v13, v13, v39
    v_add_f32 v13, v13, v40
    v_add_f32 v13, v13, v41
    v_add_f32 v13, v13, v42
    v_add_f32 v13, v13, v43
    v_add_f32 v13, v13, v44
    v_add_f32 v13, v13, v45
    v_add_f32 v13, v13, v46
    v_add_f32 v13, v13, v47
    v_add_f32 v13, v13, v48
    v_add_f32 v13, v13, v49
    v_add_f32 v13, v13, v50
    v_add_f32 v13, v13, v51
    v_add_f32 v13, v13, v52
    v_add_f32 v13, v13, v53
    v_add_f32 v13, v13, v54
    v_add_f32 v13, v13, v55
    v_add_f32 v13, v13, v56
    v_add_f32 v13, v13, v57
    v_add_f32 v13, v13, v58
    v_add_f32 v13, v13, v59
    v_add_f32 v13, v13, v60
    v_add_f32 v13, v13, v61
    v_add_f32 v13, v13, v62
    v_add_f32 v13, v13, v63
    ds_read_b32 v32, v11 offset:32768
    ds_read_b32 v33, v11 offset:33792
    ds_read_b32 v34, v11 offset:34816
    ds_read_b32 v35, v11 offset:35840
    ds_read_b32 v36, v11 offset:36864
    ds_read_b32 v37, v11 offset:37888
    ds_read_b32 v38, v11 offset:38912
    ds_read_b32 v39, v11 offset:39936
    ds_read_b32 v40, v11 offset:40960
    ds_read_b32 v41, v11 offset:41984
    ds_read_b32 v42, v11 offset:43008
    ds_read_b32 v43, v11 offset:44032
    ds_read_b32 v44, v11 offset:45056
    ds_read_b32 v45, v11 offset:46080
    ds_read_b32 v46, v11 offset:47104
    ds_read_b32 v47, v11 offset:48128
    ds_read_b32 v48, v11 offset:49152
    ds_read_b32 v49, v11 offset:50176
    ds_read_b32 v50, v11 offset:51200
    ds_read_b32 v51, v11 offset:52224
    ds_read_b32 v52, v11 offset:53248
    ds_read_b32 v53, v11 offset:54272
    ds_read_b32 v54, v11 offset:55296
    ds_read_b32 v55, v11 offset:56320
    ds_read_b32 v56, v11 offset:57344
    ds_read_b32 v57, v11 offset:58368
    ds_read_b32 v58, v11 offset:59392
    ds_read_b32 v59, v11 offset:60416
    ds_read_b32 v60, v11 offset:61440
    ds_read_b32 v61, v11 offset:62464
    ds_read_b32 v62, v11 offset:63488
    ds_read_b32 v63, v11 offset:64512
    s_waitcnt lgkmcnt(0)
    v_add_f32 v13, v13, v32
    v_add_f32 v13, v13, v33
    v_add_f32 v13, v13, v34
    v_add_f32 v13, v13, v35
    v_add_f32 v13, v13, v36
    v_add_f32 v13, v13, v37
    v_add_f32 v13, v13, v38
    v_add_f32 v13, v13, v39
    v_add_f32 v13, v13, v40
    v_add_f32 v13, v13, v41
    v_add_f32 v13, v13, v42
    v_add_f32 v13, v13, v43
    v_add_f32 v13, v13, v44
    v_add_f32 v13, v13, v45
    v_add_f32 v13, v13, v46
    v_add_f32 v13, v13, v47
    v_add_f32 v13, v13, v48
    v_add_f32 v13, v13, v49
    v_add_f32 v13, v13, v50
    v_add_f32 v13, v13, v51
    v_add_f32 v13, v13, v52
    v_add_f32 v13, v13, v53
    v_add_f32 v13, v13, v54
    v_add_f32 v13, v13, v55
    v_add_f32 v13, v13, v56
    v_add_f32 v13, v13, v57
    v_add_f32 v13, v13, v58
    v_add_f32 v13, v13, v59
    v_add_f32 v13, v13, v60
    v_add_f32 v13, v13, v61
    v_add_f32 v13, v13, v62
    v_add_f32 v13, v13, v63
    v_cvt_pk_bf16_f32 v14, v13, v13
    v_and_b32 v13, 0xffff0000, v14
    v_lshlrev_b32 v14, 2, v0
    v_add_u32 v14, 65536, v14
    ds_write_b32 v14, v13
Lffn_b1:
    s_waitcnt lgkmcnt(0)
    s_barrier
    s_cmp_ge_u32 s16, 2
    s_cbranch_scc1 Lffn_b2
    v_lshlrev_b32 v14, 2, v0
    v_add_u32 v14, 65536, v14
    ds_read_b32 v15, v14
    ds_read_b32 v16, v14 offset:512
    s_waitcnt lgkmcnt(0)
    v_mul_f32 v18, v15, v15
    v_mul_f32 v18, v18, v15
    v_fma_f32 v18, v18, s22, v15
    v_mul_f32 v18, s21, v18
    v_exp_f32 v18, v18
    s_nop 0
    v_add_f32 v18, 1.0, v18
    v_rcp_f32 v18, v18
    s_nop 0
    v_fma_f32 v19, v18, -2.0, 1.0
    v_add_f32 v19, 1.0, v19
    v_mul_f32 v19, 0.5, v19
    v_mul_f32 v17, v15, v19
    v_cvt_pk_bf16_f32 v18, v17, v17
    v_and_b32 v17, 0xffff0000, v18
    v_mul_f32 v17, v17, v16
    v_cvt_pk_bf16_f32 v18, v17, v17
    v_and_b32 v17, 0xffff0000, v18
    ds_write_b32 v14, v17 offset:1024
Lffn_b2:
    s_waitcnt lgkmcnt(0)
    s_barrier
    s_lshl_b32 s17, s14, 6
    s_lshl_b32 s18, s16, 3
    s_add_u32 s17, s17, s18
    s_mul_i32 s17, s17, 1152
    v_lshlrev_b32 v6, 5, v1
    v_add_u32 v6, s17, v6
    s_lshl_b32 s18, s16, 5
    s_add_u32 s18, s18, 66560
    v_mov_b32 v7, s18
    v_cmp_gt_u32 vcc, 36, v1
    s_nop 0
    s_and_saveexec_b64 s[24:25], vcc
    global_load_dwordx4 v[32:35], v6, s[12:13]
    global_load_dwordx4 v[36:39], v6, s[12:13] offset:16
    v_add_u32 v6, 1152, v6
    global_load_dwordx4 v[40:43], v6, s[12:13]
    global_load_dwordx4 v[44:47], v6, s[12:13] offset:16
    v_add_u32 v6, 1152, v6
    global_load_dwordx4 v[48:51], v6, s[12:13]
    global_load_dwordx4 v[52:55], v6, s[12:13] offset:16
    v_add_u32 v6, 1152, v6
    global_load_dwordx4 v[56:59], v6, s[12:13]
    global_load_dwordx4 v[60:63], v6, s[12:13] offset:16
    v_add_u32 v6, 1152, v6
    global_load_dwordx4 v[64:67], v6, s[12:13]
    global_load_dwordx4 v[68:71], v6, s[12:13] offset:16
    v_add_u32 v6, 1152, v6
    global_load_dwordx4 v[72:75], v6, s[12:13]
    global_load_dwordx4 v[76:79], v6, s[12:13] offset:16
    v_add_u32 v6, 1152, v6
    global_load_dwordx4 v[80:83], v6, s[12:13]
    global_load_dwordx4 v[84:87], v6, s[12:13] offset:16
    v_add_u32 v6, 1152, v6
    global_load_dwordx4 v[88:91], v6, s[12:13]
    global_load_dwordx4 v[92:95], v6, s[12:13] offset:16
    v_add_u32 v6, 1152, v6
    v_mov_b32 v96, 0
    v_mov_b32 v97, 0
    v_mov_b32 v98, 0
    v_mov_b32 v99, 0
    v_mov_b32 v100, 0
    v_mov_b32 v101, 0
    v_mov_b32 v102, 0
    v_mov_b32 v103, 0
    v_mov_b32 v104, 0
    v_mov_b32 v105, 0
    v_mov_b32 v106, 0
    v_mov_b32 v107, 0
    v_mov_b32 v108, 0
    v_mov_b32 v109, 0
    v_mov_b32 v110, 0
    v_mov_b32 v111, 0
    v_mov_b32 v112, 0
    v_mov_b32 v113, 0
    v_mov_b32 v114, 0
    v_mov_b32 v115, 0
    v_mov_b32 v116, 0
    v_mov_b32 v117, 0
    v_mov_b32 v118, 0
    v_mov_b32 v119, 0
    v_mov_b32 v120, 0
    v_mov_b32 v121, 0
    v_mov_b32 v122, 0
    v_mov_b32 v123, 0
    v_mov_b32 v124, 0
    v_mov_b32 v125, 0
    v_mov_b32 v126, 0
    v_mov_b32 v127, 0
    ds_read_b32 v24, v7 offset:0
    ds_read_b32 v25, v7 offset:256
    s_waitcnt vmcnt(14)
    v_lshlrev_b32 v8, 16, v32
    v_and_b32 v9, 0xffff0000, v32
    v_lshlrev_b32 v10, 16, v33
    v_and_b32 v11, 0xffff0000, v33
    v_lshlrev_b32 v12, 16, v34
    v_and_b32 v13, 0xffff0000, v34
    v_lshlrev_b32 v14, 16, v35
    v_and_b32 v15, 0xffff0000, v35
    v_lshlrev_b32 v16, 16, v36
    v_and_b32 v17, 0xffff0000, v36
    v_lshlrev_b32 v18, 16, v37
    v_and_b32 v19, 0xffff0000, v37
    v_lshlrev_b32 v20, 16, v38
    v_and_b32 v21, 0xffff0000, v38
    v_lshlrev_b32 v22, 16, v39
    v_and_b32 v23, 0xffff0000, v39
    s_waitcnt lgkmcnt(0)
    v_fmac_f32 v96, v24, v8
    v_fmac_f32 v97, v24, v9
    v_fmac_f32 v98, v24, v10
    v_fmac_f32 v99, v24, v11
    v_fmac_f32 v100, v24, v12
    v_fmac_f32 v101, v24, v13
    v_fmac_f32 v102, v24, v14
    v_fmac_f32 v103, v24, v15
    v_fmac_f32 v104, v24, v16
    v_fmac_f32 v105, v24, v17
    v_fmac_f32 v106, v24, v18
    v_fmac_f32 v107, v24, v19
    v_fmac_f32 v108, v24, v20
    v_fmac_f32 v109, v24, v21
    v_fmac_f32 v110, v24, v22
    v_fmac_f32 v111, v24, v23
    v_fmac_f32 v112, v25, v8
    v_fmac_f32 v113, v25, v9
    v_fmac_f32 v114, v25, v10
    v_fmac_f32 v115, v25, v11
    v_fmac_f32 v116, v25, v12
    v_fmac_f32 v117, v25, v13
    v_fmac_f32 v118, v25, v14
    v_fmac_f32 v119, v25, v15
    v_fmac_f32 v120, v25, v16
    v_fmac_f32 v121, v25, v17
    v_fmac_f32 v122, v25, v18
    v_fmac_f32 v123, v25, v19
    v_fmac_f32 v124, v25, v20
    v_fmac_f32 v125, v25, v21
    v_fmac_f32 v126, v25, v22
    v_fmac_f32 v127, v25, v23
    ds_read_b32 v24, v7 offset:4
    ds_read_b32 v25, v7 offset:260
    s_waitcnt vmcnt(12)
    v_lshlrev_b32 v8, 16, v40
    v_and_b32 v9, 0xffff0000, v40
    v_lshlrev_b32 v10, 16, v41
    v_and_b32 v11, 0xffff0000, v41
    v_lshlrev_b32 v12, 16, v42
    v_and_b32 v13, 0xffff0000, v42
    v_lshlrev_b32 v14, 16, v43
    v_and_b32 v15, 0xffff0000, v43
    v_lshlrev_b32 v16, 16, v44
    v_and_b32 v17, 0xffff0000, v44
    v_lshlrev_b32 v18, 16, v45
    v_and_b32 v19, 0xffff0000, v45
    v_lshlrev_b32 v20, 16, v46
    v_and_b32 v21, 0xffff0000, v46
    v_lshlrev_b32 v22, 16, v47
    v_and_b32 v23, 0xffff0000, v47
    s_waitcnt lgkmcnt(0)
    v_fmac_f32 v96, v24, v8
    v_fmac_f32 v97, v24, v9
    v_fmac_f32 v98, v24, v10
    v_fmac_f32 v99, v24, v11
    v_fmac_f32 v100, v24, v12
    v_fmac_f32 v101, v24, v13
    v_fmac_f32 v102, v24, v14
    v_fmac_f32 v103, v24, v15
    v_fmac_f32 v104, v24, v16
    v_fmac_f32 v105, v24, v17
    v_fmac_f32 v106, v24, v18
    v_fmac_f32 v107, v24, v19
    v_fmac_f32 v108, v24, v20
    v_fmac_f32 v109, v24, v21
    v_fmac_f32 v110, v24, v22
    v_fmac_f32 v111, v24, v23
    v_fmac_f32 v112, v25, v8
    v_fmac_f32 v113, v25, v9
    v_fmac_f32 v114, v25, v10
    v_fmac_f32 v115, v25, v11
    v_fmac_f32 v116, v25, v12
    v_fmac_f32 v117, v25, v13
    v_fmac_f32 v118, v25, v14
    v_fmac_f32 v119, v25, v15
    v_fmac_f32 v120, v25, v16
    v_fmac_f32 v121, v25, v17
    v_fmac_f32 v122, v25, v18
    v_fmac_f32 v123, v25, v19
    v_fmac_f32 v124, v25, v20
    v_fmac_f32 v125, v25, v21
    v_fmac_f32 v126, v25, v22
    v_fmac_f32 v127, v25, v23
    ds_read_b32 v24, v7 offset:8
    ds_read_b32 v25, v7 offset:264
    s_waitcnt vmcnt(10)
    v_lshlrev_b32 v8, 16, v48
    v_and_b32 v9, 0xffff0000, v48
    v_lshlrev_b32 v10, 16, v49
    v_and_b32 v11, 0xffff0000, v49
    v_lshlrev_b32 v12, 16, v50
    v_and_b32 v13, 0xffff0000, v50
    v_lshlrev_b32 v14, 16, v51
    v_and_b32 v15, 0xffff0000, v51
    v_lshlrev_b32 v16, 16, v52
    v_and_b32 v17, 0xffff0000, v52
    v_lshlrev_b32 v18, 16, v53
    v_and_b32 v19, 0xffff0000, v53
    v_lshlrev_b32 v20, 16, v54
    v_and_b32 v21, 0xffff0000, v54
    v_lshlrev_b32 v22, 16, v55
    v_and_b32 v23, 0xffff0000, v55
    s_waitcnt lgkmcnt(0)
    v_fmac_f32 v96, v24, v8
    v_fmac_f32 v97, v24, v9
    v_fmac_f32 v98, v24, v10
    v_fmac_f32 v99, v24, v11
    v_fmac_f32 v100, v24, v12
    v_fmac_f32 v101, v24, v13
    v_fmac_f32 v102, v24, v14
    v_fmac_f32 v103, v24, v15
    v_fmac_f32 v104, v24, v16
    v_fmac_f32 v105, v24, v17
    v_fmac_f32 v106, v24, v18
    v_fmac_f32 v107, v24, v19
    v_fmac_f32 v108, v24, v20
    v_fmac_f32 v109, v24, v21
    v_fmac_f32 v110, v24, v22
    v_fmac_f32 v111, v24, v23
    v_fmac_f32 v112, v25, v8
    v_fmac_f32 v113, v25, v9
    v_fmac_f32 v114, v25, v10
    v_fmac_f32 v115, v25, v11
    v_fmac_f32 v116, v25, v12
    v_fmac_f32 v117, v25, v13
    v_fmac_f32 v118, v25, v14
    v_fmac_f32 v119, v25, v15
    v_fmac_f32 v120, v25, v16
    v_fmac_f32 v121, v25, v17
    v_fmac_f32 v122, v25, v18
    v_fmac_f32 v123, v25, v19
    v_fmac_f32 v124, v25, v20
    v_fmac_f32 v125, v25, v21
    v_fmac_f32 v126, v25, v22
    v_fmac_f32 v127, v25, v23
    ds_read_b32 v24, v7 offset:12
    ds_read_b32 v25, v7 offset:268
    s_waitcnt vmcnt(8)
    v_lshlrev_b32 v8, 16, v56
    v_and_b32 v9, 0xffff0000, v56
    v_lshlrev_b32 v10, 16, v57
    v_and_b32 v11, 0xffff0000, v57
    v_lshlrev_b32 v12, 16, v58
    v_and_b32 v13, 0xffff0000, v58
    v_lshlrev_b32 v14, 16, v59
    v_and_b32 v15, 0xffff0000, v59
    v_lshlrev_b32 v16, 16, v60
    v_and_b32 v17, 0xffff0000, v60
    v_lshlrev_b32 v18, 16, v61
    v_and_b32 v19, 0xffff0000, v61
    v_lshlrev_b32 v20, 16, v62
    v_and_b32 v21, 0xffff0000, v62
    v_lshlrev_b32 v22, 16, v63
    v_and_b32 v23, 0xffff0000, v63
    s_waitcnt lgkmcnt(0)
    v_fmac_f32 v96, v24, v8
    v_fmac_f32 v97, v24, v9
    v_fmac_f32 v98, v24, v10
    v_fmac_f32 v99, v24, v11
    v_fmac_f32 v100, v24, v12
    v_fmac_f32 v101, v24, v13
    v_fmac_f32 v102, v24, v14
    v_fmac_f32 v103, v24, v15
    v_fmac_f32 v104, v24, v16
    v_fmac_f32 v105, v24, v17
    v_fmac_f32 v106, v24, v18
    v_fmac_f32 v107, v24, v19
    v_fmac_f32 v108, v24, v20
    v_fmac_f32 v109, v24, v21
    v_fmac_f32 v110, v24, v22
    v_fmac_f32 v111, v24, v23
    v_fmac_f32 v112, v25, v8
    v_fmac_f32 v113, v25, v9
    v_fmac_f32 v114, v25, v10
    v_fmac_f32 v115, v25, v11
    v_fmac_f32 v116, v25, v12
    v_fmac_f32 v117, v25, v13
    v_fmac_f32 v118, v25, v14
    v_fmac_f32 v119, v25, v15
    v_fmac_f32 v120, v25, v16
    v_fmac_f32 v121, v25, v17
    v_fmac_f32 v122, v25, v18
    v_fmac_f32 v123, v25, v19
    v_fmac_f32 v124, v25, v20
    v_fmac_f32 v125, v25, v21
    v_fmac_f32 v126, v25, v22
    v_fmac_f32 v127, v25, v23
    ds_read_b32 v24, v7 offset:16
    ds_read_b32 v25, v7 offset:272
    s_waitcnt vmcnt(6)
    v_lshlrev_b32 v8, 16, v64
    v_and_b32 v9, 0xffff0000, v64
    v_lshlrev_b32 v10, 16, v65
    v_and_b32 v11, 0xffff0000, v65
    v_lshlrev_b32 v12, 16, v66
    v_and_b32 v13, 0xffff0000, v66
    v_lshlrev_b32 v14, 16, v67
    v_and_b32 v15, 0xffff0000, v67
    v_lshlrev_b32 v16, 16, v68
    v_and_b32 v17, 0xffff0000, v68
    v_lshlrev_b32 v18, 16, v69
    v_and_b32 v19, 0xffff0000, v69
    v_lshlrev_b32 v20, 16, v70
    v_and_b32 v21, 0xffff0000, v70
    v_lshlrev_b32 v22, 16, v71
    v_and_b32 v23, 0xffff0000, v71
    s_waitcnt lgkmcnt(0)
    v_fmac_f32 v96, v24, v8
    v_fmac_f32 v97, v24, v9
    v_fmac_f32 v98, v24, v10
    v_fmac_f32 v99, v24, v11
    v_fmac_f32 v100, v24, v12
    v_fmac_f32 v101, v24, v13
    v_fmac_f32 v102, v24, v14
    v_fmac_f32 v103, v24, v15
    v_fmac_f32 v104, v24, v16
    v_fmac_f32 v105, v24, v17
    v_fmac_f32 v106, v24, v18
    v_fmac_f32 v107, v24, v19
    v_fmac_f32 v108, v24, v20
    v_fmac_f32 v109, v24, v21
    v_fmac_f32 v110, v24, v22
    v_fmac_f32 v111, v24, v23
    v_fmac_f32 v112, v25, v8
    v_fmac_f32 v113, v25, v9
    v_fmac_f32 v114, v25, v10
    v_fmac_f32 v115, v25, v11
    v_fmac_f32 v116, v25, v12
    v_fmac_f32 v117, v25, v13
    v_fmac_f32 v118, v25, v14
    v_fmac_f32 v119, v25, v15
    v_fmac_f32 v120, v25, v16
    v_fmac_f32 v121, v25, v17
    v_fmac_f32 v122, v25, v18
    v_fmac_f32 v123, v25, v19
    v_fmac_f32 v124, v25, v20
    v_fmac_f32 v125, v25, v21
    v_fmac_f32 v126, v25, v22
    v_fmac_f32 v127, v25, v23
    ds_read_b32 v24, v7 offset:20
    ds_read_b32 v25, v7 offset:276
    s_waitcnt vmcnt(4)
    v_lshlrev_b32 v8, 16, v72
    v_and_b32 v9, 0xffff0000, v72
    v_lshlrev_b32 v10, 16, v73
    v_and_b32 v11, 0xffff0000, v73
    v_lshlrev_b32 v12, 16, v74
    v_and_b32 v13, 0xffff0000, v74
    v_lshlrev_b32 v14, 16, v75
    v_and_b32 v15, 0xffff0000, v75
    v_lshlrev_b32 v16, 16, v76
    v_and_b32 v17, 0xffff0000, v76
    v_lshlrev_b32 v18, 16, v77
    v_and_b32 v19, 0xffff0000, v77
    v_lshlrev_b32 v20, 16, v78
    v_and_b32 v21, 0xffff0000, v78
    v_lshlrev_b32 v22, 16, v79
    v_and_b32 v23, 0xffff0000, v79
    s_waitcnt lgkmcnt(0)
    v_fmac_f32 v96, v24, v8
    v_fmac_f32 v97, v24, v9
    v_fmac_f32 v98, v24, v10
    v_fmac_f32 v99, v24, v11
    v_fmac_f32 v100, v24, v12
    v_fmac_f32 v101, v24, v13
    v_fmac_f32 v102, v24, v14
    v_fmac_f32 v103, v24, v15
    v_fmac_f32 v104, v24, v16
    v_fmac_f32 v105, v24, v17
    v_fmac_f32 v106, v24, v18
    v_fmac_f32 v107, v24, v19
    v_fmac_f32 v108, v24, v20
    v_fmac_f32 v109, v24, v21
    v_fmac_f32 v110, v24, v22
    v_fmac_f32 v111, v24, v23
    v_fmac_f32 v112, v25, v8
    v_fmac_f32 v113, v25, v9
    v_fmac_f32 v114, v25, v10
    v_fmac_f32 v115, v25, v11
    v_fmac_f32 v116, v25, v12
    v_fmac_f32 v117, v25, v13
    v_fmac_f32 v118, v25, v14
    v_fmac_f32 v119, v25, v15
    v_fmac_f32 v120, v25, v16
    v_fmac_f32 v121, v25, v17
    v_fmac_f32 v122, v25, v18
    v_fmac_f32 v123, v25, v19
    v_fmac_f32 v124, v25, v20
    v_fmac_f32 v125, v25, v21
    v_fmac_f32 v126, v25, v22
    v_fmac_f32 v127, v25, v23
    ds_read_b32 v24, v7 offset:24
    ds_read_b32 v25, v7 offset:280
    s_waitcnt vmcnt(2)
    v_lshlrev_b32 v8, 16, v80
    v_and_b32 v9, 0xffff0000, v80
    v_lshlrev_b32 v10, 16, v81
    v_and_b32 v11, 0xffff0000, v81
    v_lshlrev_b32 v12, 16, v82
    v_and_b32 v13, 0xffff0000, v82
    v_lshlrev_b32 v14, 16, v83
    v_and_b32 v15, 0xffff0000, v83
    v_lshlrev_b32 v16, 16, v84
    v_and_b32 v17, 0xffff0000, v84
    v_lshlrev_b32 v18, 16, v85
    v_and_b32 v19, 0xffff0000, v85
    v_lshlrev_b32 v20, 16, v86
    v_and_b32 v21, 0xffff0000, v86
    v_lshlrev_b32 v22, 16, v87
    v_and_b32 v23, 0xffff0000, v87
    s_waitcnt lgkmcnt(0)
    v_fmac_f32 v96, v24, v8
    v_fmac_f32 v97, v24, v9
    v_fmac_f32 v98, v24, v10
    v_fmac_f32 v99, v24, v11
    v_fmac_f32 v100, v24, v12
    v_fmac_f32 v101, v24, v13
    v_fmac_f32 v102, v24, v14
    v_fmac_f32 v103, v24, v15
    v_fmac_f32 v104, v24, v16
    v_fmac_f32 v105, v24, v17
    v_fmac_f32 v106, v24, v18
    v_fmac_f32 v107, v24, v19
    v_fmac_f32 v108, v24, v20
    v_fmac_f32 v109, v24, v21
    v_fmac_f32 v110, v24, v22
    v_fmac_f32 v111, v24, v23
    v_fmac_f32 v112, v25, v8
    v_fmac_f32 v113, v25, v9
    v_fmac_f32 v114, v25, v10
    v_fmac_f32 v115, v25, v11
    v_fmac_f32 v116, v25, v12
    v_fmac_f32 v117, v25, v13
    v_fmac_f32 v118, v25, v14
    v_fmac_f32 v119, v25, v15
    v_fmac_f32 v120, v25, v16
    v_fmac_f32 v121, v25, v17
    v_fmac_f32 v122, v25, v18
    v_fmac_f32 v123, v25, v19
    v_fmac_f32 v124, v25, v20
    v_fmac_f32 v125, v25, v21
    v_fmac_f32 v126, v25, v22
    v_fmac_f32 v127, v25, v23
    ds_read_b32 v24, v7 offset:28
    ds_read_b32 v25, v7 offset:284
    s_waitcnt vmcnt(0)
    v_lshlrev_b32 v8, 16, v88
    v_and_b32 v9, 0xffff0000, v88
    v_lshlrev_b32 v10, 16, v89
    v_and_b32 v11, 0xffff0000, v89
    v_lshlrev_b32 v12, 16, v90
    v_and_b32 v13, 0xffff0000, v90
    v_lshlrev_b32 v14, 16, v91
    v_and_b32 v15, 0xffff0000, v91
    v_lshlrev_b32 v16, 16, v92
    v_and_b32 v17, 0xffff0000, v92
    v_lshlrev_b32 v18, 16, v93
    v_and_b32 v19, 0xffff0000, v93
    v_lshlrev_b32 v20, 16, v94
    v_and_b32 v21, 0xffff0000, v94
    v_lshlrev_b32 v22, 16, v95
    v_and_b32 v23, 0xffff0000, v95
    s_waitcnt lgkmcnt(0)
    v_fmac_f32 v96, v24, v8
    v_fmac_f32 v97, v24, v9
    v_fmac_f32 v98, v24, v10
    v_fmac_f32 v99, v24, v11
    v_fmac_f32 v100, v24, v12
    v_fmac_f32 v101, v24, v13
    v_fmac_f32 v102, v24, v14
    v_fmac_f32 v103, v24, v15
    v_fmac_f32 v104, v24, v16
    v_fmac_f32 v105, v24, v17
    v_fmac_f32 v106, v24, v18
    v_fmac_f32 v107, v24, v19
    v_fmac_f32 v108, v24, v20
    v_fmac_f32 v109, v24, v21
    v_fmac_f32 v110, v24, v22
    v_fmac_f32 v111, v24, v23
    v_fmac_f32 v112, v25, v8
    v_fmac_f32 v113, v25, v9
    v_fmac_f32 v114, v25, v10
    v_fmac_f32 v115, v25, v11
    v_fmac_f32 v116, v25, v12
    v_fmac_f32 v117, v25, v13
    v_fmac_f32 v118, v25, v14
    v_fmac_f32 v119, v25, v15
    v_fmac_f32 v120, v25, v16
    v_fmac_f32 v121, v25, v17
    v_fmac_f32 v122, v25, v18
    v_fmac_f32 v123, v25, v19
    v_fmac_f32 v124, v25, v20
    v_fmac_f32 v125, v25, v21
    v_fmac_f32 v126, v25, v22
    v_fmac_f32 v127, v25, v23
    v_lshlrev_b32 v6, 6, v1
    s_mul_i32 s18, s16, 4608
    v_add_u32 v6, s18, v6
    ds_write_b128 v6, v[96:99] offset:0
    ds_write_b128 v6, v[100:103] offset:16
    ds_write_b128 v6, v[104:107] offset:32
    ds_write_b128 v6, v[108:111] offset:48
    ds_write_b128 v6, v[112:115] offset:2304
    ds_write_b128 v6, v[116:119] offset:2320
    ds_write_b128 v6, v[120:123] offset:2336
    ds_write_b128 v6, v[124:127] offset:2352
    s_mov_b64 exec, s[24:25]
    s_waitcnt lgkmcnt(0)
    s_barrier
    v_lshlrev_b32 v6, 2, v0
    s_mul_i32 s18, s14, 4608
    v_add_u32 v7, s18, v6
    ds_read_b32 v32, v6 offset:0
    ds_read_b32 v33, v6 offset:4608
    ds_read_b32 v34, v6 offset:9216
    ds_read_b32 v35, v6 offset:13824
    ds_read_b32 v36, v6 offset:18432
    ds_read_b32 v37, v6 offset:23040
    ds_read_b32 v38, v6 offset:27648
    ds_read_b32 v39, v6 offset:32256
    s_waitcnt lgkmcnt(0)
    v_add_f32 v8, v32, v33
    v_add_f32 v8, v8, v34
    v_add_f32 v8, v8, v35
    v_add_f32 v8, v8, v36
    v_add_f32 v8, v8, v37
    v_add_f32 v8, v8, v38
    v_add_f32 v8, v8, v39
    v_add_u32 v9, 524288, v7
    global_store_dword v9, v8, s[8:9]
    ds_read_b32 v32, v6 offset:2048
    ds_read_b32 v33, v6 offset:6656
    ds_read_b32 v34, v6 offset:11264
    ds_read_b32 v35, v6 offset:15872
    ds_read_b32 v36, v6 offset:20480
    ds_read_b32 v37, v6 offset:25088
    ds_read_b32 v38, v6 offset:29696
    ds_read_b32 v39, v6 offset:34304
    s_waitcnt lgkmcnt(0)
    v_add_f32 v8, v32, v33
    v_add_f32 v8, v8, v34
    v_add_f32 v8, v8, v35
    v_add_f32 v8, v8, v36
    v_add_f32 v8, v8, v37
    v_add_f32 v8, v8, v38
    v_add_f32 v8, v8, v39
    v_add_u32 v9, 526336, v7
    global_store_dword v9, v8, s[8:9]
    v_cmp_gt_u32 vcc, 128, v0
    s_nop 0
    s_and_saveexec_b64 s[24:25], vcc
    s_cbranch_execz La_end
    ds_read_b32 v32, v6 offset:4096
    ds_read_b32 v33, v6 offset:8704
    ds_read_b32 v34, v6 offset:13312
    ds_read_b32 v35, v6 offset:17920
    ds_read_b32 v36, v6 offset:22528
    ds_read_b32 v37, v6 offset:27136
    ds_read_b32 v38, v6 offset:31744
    ds_read_b32 v39, v6 offset:36352
    s_waitcnt lgkmcnt(0)
    v_add_f32 v8, v32, v33
    v_add_f32 v8, v8, v34
    v_add_f32 v8, v8, v35
    v_add_f32 v8, v8, v36
    v_add_f32 v8, v8, v37
    v_add_f32 v8, v8, v38
    v_add_f32 v8, v8, v39
    v_add_u32 v9, 528384, v7
    global_store_dword v9, v8, s[8:9]
La_end:
    s_endpgm
.section .rodata,"a"
.p2align 6
.amdhsa_kernel gated_mix__gqa_block_cached__glu_gated_geglu__decode_kernel
  .amdhsa_next_free_vgpr 160
  .amdhsa_next_free_sgpr 64
  .amdhsa_accum_offset 160
  .amdhsa_group_segment_fixed_size 0
  .amdhsa_kernarg_size 104
  .amdhsa_user_sgpr_count 2
  .amdhsa_user_sgpr_kernarg_segment_ptr 1
  .amdhsa_system_sgpr_workgroup_id_x 1
.end_amdhsa_kernel
.text
.globl oproj_kernel
.p2align 8
.type oproj_kernel,@function
oproj_kernel:
    s_cmp_ge_u32 s2, 288
    s_cbranch_scc1 Lo_end
    s_load_dwordx2 s[4:5], s[0:1], 32
    s_load_dwordx2 s[8:9], s[0:1], 96
    s_load_dwordx2 s[24:25], s[0:1], 0
    s_load_dwordx2 s[26:27], s[0:1], 72
    s_load_dwordx2 s[28:29], s[0:1], 80
    s_load_dwordx2 s[30:31], s[0:1], 88
    s_mov_b32 s10, 0x1c71c71d
    s_mul_hi_u32 s11, s2, s10
    s_mul_i32 s12, s11, 9
    s_sub_u32 s12, s2, s12
    v_and_b32 v1, 63, v0
    v_lshrrev_b32 v2, 6, v0
    v_lshrrev_b32 v3, 3, v1
    v_and_b32 v4, 7, v1
    v_lshl_add_u32 v5, v2, 5, v3
    s_lshl_b32 s13, s11, 7
    v_add_u32 v6, s13, v5
    v_mul_u32_u24 v6, 1152, v6
    v_lshl_add_u32 v6, v4, 4, v6
    s_lshl_b32 s14, s12, 7
    v_add_u32 v6, s14, v6
    s_mov_b32 s20, 0x3e0293ee
    s_waitcnt lgkmcnt(0)
    global_load_dwordx4 v[16:19], v6, s[4:5]
    v_add_u32 v6, 9216, v6
    global_load_dwordx4 v[20:23], v6, s[4:5]
    v_add_u32 v6, 9216, v6
    global_load_dwordx4 v[24:27], v6, s[4:5]
    v_add_u32 v6, 9216, v6
    global_load_dwordx4 v[28:31], v6, s[4:5]
    v_add_u32 v6, 9216, v6
    v_lshrrev_b32 v7, 7, v0
    v_and_b32 v8, 127, v0
    s_lshr_b32 s15, s11, 1
    s_and_b32 s16, s11, 1
    v_lshlrev_b32 v9, 4, v7
    v_add_u32 v9, s15, v9
    v_lshlrev_b32 v10, 7, v9
    s_lshl_b32 s17, s16, 3
    v_add_u32 v10, s17, v10
    v_lshlrev_b32 v11, 13, v9
    s_lshl_b32 s17, s16, 9
    v_add_u32 v11, s17, v11
    v_lshl_add_u32 v11, v8, 2, v11
    v_add_u32 v10, 393216, v10
    v_add_u32 v11, 131072, v11
    global_load_dwordx2 v[32:33], v10, s[8:9] offset:0
    global_load_dword v48, v11, s[8:9]
    v_add_u32 v11, 1024, v11
    global_load_dwordx2 v[34:35], v10, s[8:9] offset:16
    global_load_dword v49, v11, s[8:9]
    v_add_u32 v11, 1024, v11
    global_load_dwordx2 v[36:37], v10, s[8:9] offset:32
    global_load_dword v50, v11, s[8:9]
    v_add_u32 v11, 1024, v11
    global_load_dwordx2 v[38:39], v10, s[8:9] offset:48
    global_load_dword v51, v11, s[8:9]
    v_add_u32 v11, 1024, v11
    global_load_dwordx2 v[40:41], v10, s[8:9] offset:64
    global_load_dword v52, v11, s[8:9]
    v_add_u32 v11, 1024, v11
    global_load_dwordx2 v[42:43], v10, s[8:9] offset:80
    global_load_dword v53, v11, s[8:9]
    v_add_u32 v11, 1024, v11
    global_load_dwordx2 v[44:45], v10, s[8:9] offset:96
    global_load_dword v54, v11, s[8:9]
    v_add_u32 v11, 1024, v11
    global_load_dwordx2 v[46:47], v10, s[8:9] offset:112
    global_load_dword v55, v11, s[8:9]
    v_add_u32 v11, 1024, v11
    s_waitcnt vmcnt(0)
    v_max_f32 v12, v32, v34
    v_max_f32 v12, v12, v36
    v_max_f32 v12, v12, v38
    v_max_f32 v12, v12, v40
    v_max_f32 v12, v12, v42
    v_max_f32 v12, v12, v44
    v_max_f32 v12, v12, v46
    v_mul_f32 v13, s20, v12
    v_fma_f32 v32, v32, s20, -v13
    v_fma_f32 v34, v34, s20, -v13
    v_fma_f32 v36, v36, s20, -v13
    v_fma_f32 v38, v38, s20, -v13
    v_fma_f32 v40, v40, s20, -v13
    v_fma_f32 v42, v42, s20, -v13
    v_fma_f32 v44, v44, s20, -v13
    v_fma_f32 v46, v46, s20, -v13
    v_exp_f32 v32, v32
    v_exp_f32 v34, v34
    v_exp_f32 v36, v36
    v_exp_f32 v38, v38
    v_exp_f32 v40, v40
    v_exp_f32 v42, v42
    v_exp_f32 v44, v44
    v_exp_f32 v46, v46
    v_mov_b32 v14, 0
    v_mov_b32 v15, 0
    v_fmac_f32 v14, v32, v33
    v_fmac_f32 v15, v32, v48
    v_fmac_f32 v14, v34, v35
    v_fmac_f32 v15, v34, v49
    v_fmac_f32 v14, v36, v37
    v_fmac_f32 v15, v36, v50
    v_fmac_f32 v14, v38, v39
    v_fmac_f32 v15, v38, v51
    v_fmac_f32 v14, v40, v41
    v_fmac_f32 v15, v40, v52
    v_fmac_f32 v14, v42, v43
    v_fmac_f32 v15, v42, v53
    v_fmac_f32 v14, v44, v45
    v_fmac_f32 v15, v44, v54
    v_fmac_f32 v14, v46, v47
    v_fmac_f32 v15, v46, v55
    v_rcp_f32 v14, v14
    s_nop 0
    v_mul_f32 v15, v15, v14
    v_cvt_pk_bf16_f32 v14, v15, v15
    v_and_b32 v15, 0xffff0000, v14
    v_lshlrev_b32 v14, 2, v0
    ds_write_b32 v14, v15
    s_waitcnt lgkmcnt(0)
    s_barrier
    v_lshlrev_b32 v14, 2, v5
    v_mov_b32 v56, 0
    v_mov_b32 v57, 0
    v_mov_b32 v58, 0
    v_mov_b32 v59, 0
    v_mov_b32 v60, 0
    v_mov_b32 v61, 0
    v_mov_b32 v62, 0
    v_mov_b32 v63, 0
    v_mov_b32 v64, 0
    v_mov_b32 v65, 0
    v_mov_b32 v66, 0
    v_mov_b32 v67, 0
    v_mov_b32 v68, 0
    v_mov_b32 v69, 0
    v_mov_b32 v70, 0
    v_mov_b32 v71, 0
    ds_read_b32 v32, v14 offset:0
    ds_read_b32 v33, v14 offset:512
    ds_read_b32 v34, v14 offset:32
    ds_read_b32 v35, v14 offset:544
    ds_read_b32 v36, v14 offset:64
    ds_read_b32 v37, v14 offset:576
    ds_read_b32 v38, v14 offset:96
    ds_read_b32 v39, v14 offset:608
    s_waitcnt lgkmcnt(0)
    v_lshlrev_b32 v40, 16, v16
    v_and_b32 v41, 0xffff0000, v16
    v_lshlrev_b32 v42, 16, v17
    v_and_b32 v43, 0xffff0000, v17
    v_lshlrev_b32 v44, 16, v18
    v_and_b32 v45, 0xffff0000, v18
    v_lshlrev_b32 v46, 16, v19
    v_and_b32 v47, 0xffff0000, v19
    v_fmac_f32 v56, v32, v40
    v_fmac_f32 v57, v32, v41
    v_fmac_f32 v58, v32, v42
    v_fmac_f32 v59, v32, v43
    v_fmac_f32 v60, v32, v44
    v_fmac_f32 v61, v32, v45
    v_fmac_f32 v62, v32, v46
    v_fmac_f32 v63, v32, v47
    v_fmac_f32 v64, v33, v40
    v_fmac_f32 v65, v33, v41
    v_fmac_f32 v66, v33, v42
    v_fmac_f32 v67, v33, v43
    v_fmac_f32 v68, v33, v44
    v_fmac_f32 v69, v33, v45
    v_fmac_f32 v70, v33, v46
    v_fmac_f32 v71, v33, v47
    v_lshlrev_b32 v40, 16, v20
    v_and_b32 v41, 0xffff0000, v20
    v_lshlrev_b32 v42, 16, v21
    v_and_b32 v43, 0xffff0000, v21
    v_lshlrev_b32 v44, 16, v22
    v_and_b32 v45, 0xffff0000, v22
    v_lshlrev_b32 v46, 16, v23
    v_and_b32 v47, 0xffff0000, v23
    v_fmac_f32 v56, v34, v40
    v_fmac_f32 v57, v34, v41
    v_fmac_f32 v58, v34, v42
    v_fmac_f32 v59, v34, v43
    v_fmac_f32 v60, v34, v44
    v_fmac_f32 v61, v34, v45
    v_fmac_f32 v62, v34, v46
    v_fmac_f32 v63, v34, v47
    v_fmac_f32 v64, v35, v40
    v_fmac_f32 v65, v35, v41
    v_fmac_f32 v66, v35, v42
    v_fmac_f32 v67, v35, v43
    v_fmac_f32 v68, v35, v44
    v_fmac_f32 v69, v35, v45
    v_fmac_f32 v70, v35, v46
    v_fmac_f32 v71, v35, v47
    v_lshlrev_b32 v40, 16, v24
    v_and_b32 v41, 0xffff0000, v24
    v_lshlrev_b32 v42, 16, v25
    v_and_b32 v43, 0xffff0000, v25
    v_lshlrev_b32 v44, 16, v26
    v_and_b32 v45, 0xffff0000, v26
    v_lshlrev_b32 v46, 16, v27
    v_and_b32 v47, 0xffff0000, v27
    v_fmac_f32 v56, v36, v40
    v_fmac_f32 v57, v36, v41
    v_fmac_f32 v58, v36, v42
    v_fmac_f32 v59, v36, v43
    v_fmac_f32 v60, v36, v44
    v_fmac_f32 v61, v36, v45
    v_fmac_f32 v62, v36, v46
    v_fmac_f32 v63, v36, v47
    v_fmac_f32 v64, v37, v40
    v_fmac_f32 v65, v37, v41
    v_fmac_f32 v66, v37, v42
    v_fmac_f32 v67, v37, v43
    v_fmac_f32 v68, v37, v44
    v_fmac_f32 v69, v37, v45
    v_fmac_f32 v70, v37, v46
    v_fmac_f32 v71, v37, v47
    v_lshlrev_b32 v40, 16, v28
    v_and_b32 v41, 0xffff0000, v28
    v_lshlrev_b32 v42, 16, v29
    v_and_b32 v43, 0xffff0000, v29
    v_lshlrev_b32 v44, 16, v30
    v_and_b32 v45, 0xffff0000, v30
    v_lshlrev_b32 v46, 16, v31
    v_and_b32 v47, 0xffff0000, v31
    v_fmac_f32 v56, v38, v40
    v_fmac_f32 v57, v38, v41
    v_fmac_f32 v58, v38, v42
    v_fmac_f32 v59, v38, v43
    v_fmac_f32 v60, v38, v44
    v_fmac_f32 v61, v38, v45
    v_fmac_f32 v62, v38, v46
    v_fmac_f32 v63, v38, v47
    v_fmac_f32 v64, v39, v40
    v_fmac_f32 v65, v39, v41
    v_fmac_f32 v66, v39, v42
    v_fmac_f32 v67, v39, v43
    v_fmac_f32 v68, v39, v44
    v_fmac_f32 v69, v39, v45
    v_fmac_f32 v70, v39, v46
    v_fmac_f32 v71, v39, v47
    v_lshlrev_b32 v14, 6, v0
    ds_write_b128 v14, v[56:59] offset:1024
    ds_write_b128 v14, v[60:63] offset:1040
    ds_write_b128 v14, v[64:67] offset:1056
    ds_write_b128 v14, v[68:71] offset:1072
    s_waitcnt lgkmcnt(0)
    s_barrier
    v_cmp_gt_u32 vcc, 128, v0
    s_nop 0
    s_and_saveexec_b64 s[18:19], vcc
    s_cbranch_execz Lo_skip
    v_lshrrev_b32 v9, 6, v0
    v_and_b32 v10, 63, v0
    v_lshrrev_b32 v11, 3, v10
    v_and_b32 v12, 7, v10
    v_lshlrev_b32 v11, 6, v11
    v_lshl_add_u32 v12, v9, 3, v12
    v_lshl_add_u32 v11, v12, 2, v11
    v_mov_b32 v13, 0
    ds_read_b32 v20, v11 offset:1024
    ds_read_b32 v21, v11 offset:1536
    ds_read_b32 v22, v11 offset:2048
    ds_read_b32 v23, v11 offset:2560
    ds_read_b32 v24, v11 offset:3072
    ds_read_b32 v25, v11 offset:3584
    ds_read_b32 v26, v11 offset:4096
    ds_read_b32 v27, v11 offset:4608
    ds_read_b32 v28, v11 offset:5120
    ds_read_b32 v29, v11 offset:5632
    ds_read_b32 v30, v11 offset:6144
    ds_read_b32 v31, v11 offset:6656
    ds_read_b32 v32, v11 offset:7168
    ds_read_b32 v33, v11 offset:7680
    ds_read_b32 v34, v11 offset:8192
    ds_read_b32 v35, v11 offset:8704
    ds_read_b32 v36, v11 offset:9216
    ds_read_b32 v37, v11 offset:9728
    ds_read_b32 v38, v11 offset:10240
    ds_read_b32 v39, v11 offset:10752
    ds_read_b32 v40, v11 offset:11264
    ds_read_b32 v41, v11 offset:11776
    ds_read_b32 v42, v11 offset:12288
    ds_read_b32 v43, v11 offset:12800
    ds_read_b32 v44, v11 offset:13312
    ds_read_b32 v45, v11 offset:13824
    ds_read_b32 v46, v11 offset:14336
    ds_read_b32 v47, v11 offset:14848
    ds_read_b32 v48, v11 offset:15360
    ds_read_b32 v49, v11 offset:15872
    ds_read_b32 v50, v11 offset:16384
    ds_read_b32 v51, v11 offset:16896
    s_waitcnt lgkmcnt(0)
    v_add_f32 v13, v13, v20
    v_add_f32 v13, v13, v21
    v_add_f32 v13, v13, v22
    v_add_f32 v13, v13, v23
    v_add_f32 v13, v13, v24
    v_add_f32 v13, v13, v25
    v_add_f32 v13, v13, v26
    v_add_f32 v13, v13, v27
    v_add_f32 v13, v13, v28
    v_add_f32 v13, v13, v29
    v_add_f32 v13, v13, v30
    v_add_f32 v13, v13, v31
    v_add_f32 v13, v13, v32
    v_add_f32 v13, v13, v33
    v_add_f32 v13, v13, v34
    v_add_f32 v13, v13, v35
    v_add_f32 v13, v13, v36
    v_add_f32 v13, v13, v37
    v_add_f32 v13, v13, v38
    v_add_f32 v13, v13, v39
    v_add_f32 v13, v13, v40
    v_add_f32 v13, v13, v41
    v_add_f32 v13, v13, v42
    v_add_f32 v13, v13, v43
    v_add_f32 v13, v13, v44
    v_add_f32 v13, v13, v45
    v_add_f32 v13, v13, v46
    v_add_f32 v13, v13, v47
    v_add_f32 v13, v13, v48
    v_add_f32 v13, v13, v49
    v_add_f32 v13, v13, v50
    v_add_f32 v13, v13, v51
    s_lshl_b32 s17, s12, 5
    s_add_u32 s17, s17, s11
    s_lshl_b32 s17, s17, 9
    s_add_u32 s17, s17, 1048576
    v_lshlrev_b32 v14, 2, v0
    v_add_u32 v14, s17, v14
    global_store_dword v14, v13, s[8:9] sc1
Lo_skip:
    s_mov_b64 exec, s[18:19]
    s_waitcnt vmcnt(0)
    s_barrier
    v_cmp_eq_u32 vcc, 0, v0
    s_nop 0
    s_and_saveexec_b64 s[18:19], vcc
    s_cbranch_execz Lo_noat
    s_lshl_b32 s17, s12, 2
    v_mov_b32 v14, s17
    v_mov_b32 v15, 1
    global_atomic_add v16, v14, v15, s[30:31] sc0 sc1
    s_waitcnt vmcnt(0)
    v_mov_b32 v14, 0
    ds_write_b32 v14, v16 offset:512
Lo_noat:
    s_mov_b64 exec, s[18:19]
    s_waitcnt lgkmcnt(0)
    s_barrier
    v_mov_b32 v14, 0
    ds_read_b32 v16, v14 offset:512
    s_waitcnt lgkmcnt(0)
    v_readfirstlane_b32 s17, v16
    s_cmp_lg_u32 s17, 31
    s_cbranch_scc1 Lo_end
    v_lshrrev_b32 v2, 6, v0
    s_nop 0
    v_readfirstlane_b32 s17, v2
    s_cmp_ge_u32 s17, 2
    s_cbranch_scc1 Lo_end
    v_and_b32 v1, 63, v0
    v_lshrrev_b32 v2, 6, v0
    v_mul_u32_u24 v3, 1152, v2
    v_lshl_add_u32 v3, v1, 1, v3
    v_lshlrev_b32 v4, 1, v1
    global_load_ushort v16, v3, s[24:25] offset:0
    global_load_ushort v32, v4, s[26:27] offset:0
    global_load_ushort v17, v3, s[24:25] offset:128
    global_load_ushort v33, v4, s[26:27] offset:128
    global_load_ushort v18, v3, s[24:25] offset:256
    global_load_ushort v34, v4, s[26:27] offset:256
    global_load_ushort v19, v3, s[24:25] offset:384
    global_load_ushort v35, v4, s[26:27] offset:384
    global_load_ushort v20, v3, s[24:25] offset:512
    global_load_ushort v36, v4, s[26:27] offset:512
    global_load_ushort v21, v3, s[24:25] offset:640
    global_load_ushort v37, v4, s[26:27] offset:640
    global_load_ushort v22, v3, s[24:25] offset:768
    global_load_ushort v38, v4, s[26:27] offset:768
    global_load_ushort v23, v3, s[24:25] offset:896
    global_load_ushort v39, v4, s[26:27] offset:896
    global_load_ushort v24, v3, s[24:25] offset:1024
    global_load_ushort v40, v4, s[26:27] offset:1024
    s_lshl_b32 s32, s12, 14
    s_add_u32 s32, s32, 1048576
    v_lshlrev_b32 v5, 8, v2
    v_lshl_add_u32 v5, v1, 2, v5
    v_add_u32 v5, s32, v5
    s_lshl_b32 s33, s12, 8
    s_add_u32 s33, s33, 524288
    v_mul_u32_u24 v6, 2304, v2
    v_lshl_add_u32 v6, v1, 2, v6
    v_add_u32 v6, s33, v6
    v_mov_b32 v7, 0
    v_mov_b32 v8, 0
    global_load_dword v48, v5, s[8:9] offset:0 sc1
    global_load_dword v49, v5, s[8:9] offset:512 sc1
    global_load_dword v50, v5, s[8:9] offset:1024 sc1
    global_load_dword v51, v5, s[8:9] offset:1536 sc1
    global_load_dword v52, v5, s[8:9] offset:2048 sc1
    global_load_dword v53, v5, s[8:9] offset:2560 sc1
    global_load_dword v54, v5, s[8:9] offset:3072 sc1
    global_load_dword v55, v5, s[8:9] offset:3584 sc1
    v_add_u32 v5, 4096, v5
    global_load_dword v56, v5, s[8:9] offset:0 sc1
    global_load_dword v57, v5, s[8:9] offset:512 sc1
    global_load_dword v58, v5, s[8:9] offset:1024 sc1
    global_load_dword v59, v5, s[8:9] offset:1536 sc1
    global_load_dword v60, v5, s[8:9] offset:2048 sc1
    global_load_dword v61, v5, s[8:9] offset:2560 sc1
    global_load_dword v62, v5, s[8:9] offset:3072 sc1
    global_load_dword v63, v5, s[8:9] offset:3584 sc1
    v_add_u32 v5, 4096, v5
    global_load_dword v64, v5, s[8:9] offset:0 sc1
    global_load_dword v65, v5, s[8:9] offset:512 sc1
    global_load_dword v66, v5, s[8:9] offset:1024 sc1
    global_load_dword v67, v5, s[8:9] offset:1536 sc1
    global_load_dword v68, v5, s[8:9] offset:2048 sc1
    global_load_dword v69, v5, s[8:9] offset:2560 sc1
    global_load_dword v70, v5, s[8:9] offset:3072 sc1
    global_load_dword v71, v5, s[8:9] offset:3584 sc1
    v_add_u32 v5, 4096, v5
    global_load_dword v72, v5, s[8:9] offset:0 sc1
    global_load_dword v73, v5, s[8:9] offset:512 sc1
    global_load_dword v74, v5, s[8:9] offset:1024 sc1
    global_load_dword v75, v5, s[8:9] offset:1536 sc1
    global_load_dword v76, v5, s[8:9] offset:2048 sc1
    global_load_dword v77, v5, s[8:9] offset:2560 sc1
    global_load_dword v78, v5, s[8:9] offset:3072 sc1
    global_load_dword v79, v5, s[8:9] offset:3584 sc1
    v_add_u32 v5, 4096, v5
    global_load_dword v80, v6, s[8:9]
    v_add_u32 v6, 4608, v6
    global_load_dword v81, v6, s[8:9]
    v_add_u32 v6, 4608, v6
    global_load_dword v82, v6, s[8:9]
    v_add_u32 v6, 4608, v6
    global_load_dword v83, v6, s[8:9]
    v_add_u32 v6, 4608, v6
    global_load_dword v84, v6, s[8:9]
    v_add_u32 v6, 4608, v6
    global_load_dword v85, v6, s[8:9]
    v_add_u32 v6, 4608, v6
    global_load_dword v86, v6, s[8:9]
    v_add_u32 v6, 4608, v6
    global_load_dword v87, v6, s[8:9]
    v_add_u32 v6, 4608, v6
    global_load_dword v88, v6, s[8:9]
    v_add_u32 v6, 4608, v6
    global_load_dword v89, v6, s[8:9]
    v_add_u32 v6, 4608, v6
    global_load_dword v90, v6, s[8:9]
    v_add_u32 v6, 4608, v6
    global_load_dword v91, v6, s[8:9]
    v_add_u32 v6, 4608, v6
    global_load_dword v92, v6, s[8:9]
    v_add_u32 v6, 4608, v6
    global_load_dword v93, v6, s[8:9]
    v_add_u32 v6, 4608, v6
    global_load_dword v94, v6, s[8:9]
    v_add_u32 v6, 4608, v6
    global_load_dword v95, v6, s[8:9]
    v_add_u32 v6, 4608, v6
    global_load_dword v96, v6, s[8:9]
    v_add_u32 v6, 4608, v6
    global_load_dword v97, v6, s[8:9]
    v_add_u32 v6, 4608, v6
    global_load_dword v98, v6, s[8:9]
    v_add_u32 v6, 4608, v6
    global_load_dword v99, v6, s[8:9]
    v_add_u32 v6, 4608, v6
    global_load_dword v100, v6, s[8:9]
    v_add_u32 v6, 4608, v6
    global_load_dword v101, v6, s[8:9]
    v_add_u32 v6, 4608, v6
    global_load_dword v102, v6, s[8:9]
    v_add_u32 v6, 4608, v6
    global_load_dword v103, v6, s[8:9]
    v_add_u32 v6, 4608, v6
    global_load_dword v104, v6, s[8:9]
    v_add_u32 v6, 4608, v6
    global_load_dword v105, v6, s[8:9]
    v_add_u32 v6, 4608, v6
    global_load_dword v106, v6, s[8:9]
    v_add_u32 v6, 4608, v6
    global_load_dword v107, v6, s[8:9]
    v_add_u32 v6, 4608, v6
    global_load_dword v108, v6, s[8:9]
    v_add_u32 v6, 4608, v6
    global_load_dword v109, v6, s[8:9]
    v_add_u32 v6, 4608, v6
    global_load_dword v110, v6, s[8:9]
    v_add_u32 v6, 4608, v6
    global_load_dword v111, v6, s[8:9]
    v_add_u32 v6, 4608, v6
    global_load_dword v112, v6, s[8:9]
    v_add_u32 v6, 4608, v6
    global_load_dword v113, v6, s[8:9]
    v_add_u32 v6, 4608, v6
    global_load_dword v114, v6, s[8:9]
    v_add_u32 v6, 4608, v6
    global_load_dword v115, v6, s[8:9]
    v_add_u32 v6, 4608, v6
    global_load_dword v116, v6, s[8:9]
    v_add_u32 v6, 4608, v6
    global_load_dword v117, v6, s[8:9]
    v_add_u32 v6, 4608, v6
    global_load_dword v118, v6, s[8:9]
    v_add_u32 v6, 4608, v6
    global_load_dword v119, v6, s[8:9]
    v_add_u32 v6, 4608, v6
    global_load_dword v120, v6, s[8:9]
    v_add_u32 v6, 4608, v6
    global_load_dword v121, v6, s[8:9]
    v_add_u32 v6, 4608, v6
    global_load_dword v122, v6, s[8:9]
    v_add_u32 v6, 4608, v6
    global_load_dword v123, v6, s[8:9]
    v_add_u32 v6, 4608, v6
    global_load_dword v124, v6, s[8:9]
    v_add_u32 v6, 4608, v6
    global_load_dword v125, v6, s[8:9]
    v_add_u32 v6, 4608, v6
    global_load_dword v126, v6, s[8:9]
    v_add_u32 v6, 4608, v6
    global_load_dword v127, v6, s[8:9]
    v_add_u32 v6, 4608, v6
    global_load_dword v128, v6, s[8:9]
    v_add_u32 v6, 4608, v6
    global_load_dword v129, v6, s[8:9]
    v_add_u32 v6, 4608, v6
    global_load_dword v130, v6, s[8:9]
    v_add_u32 v6, 4608, v6
    global_load_dword v131, v6, s[8:9]
    v_add_u32 v6, 4608, v6
    global_load_dword v132, v6, s[8:9]
    v_add_u32 v6, 4608, v6
    global_load_dword v133, v6, s[8:9]
    v_add_u32 v6, 4608, v6
    global_load_dword v134, v6, s[8:9]
    v_add_u32 v6, 4608, v6
    global_load_dword v135, v6, s[8:9]
    v_add_u32 v6, 4608, v6
    global_load_dword v136, v6, s[8:9]
    v_add_u32 v6, 4608, v6
    global_load_dword v137, v6, s[8:9]
    v_add_u32 v6, 4608, v6
    global_load_dword v138, v6, s[8:9]
    v_add_u32 v6, 4608, v6
    global_load_dword v139, v6, s[8:9]
    v_add_u32 v6, 4608, v6
    global_load_dword v140, v6, s[8:9]
    v_add_u32 v6, 4608, v6
    global_load_dword v141, v6, s[8:9]
    v_add_u32 v6, 4608, v6
    global_load_dword v142, v6, s[8:9]
    v_add_u32 v6, 4608, v6
    global_load_dword v143, v6, s[8:9]
    v_add_u32 v6, 4608, v6
    global_load_dword v144, v6, s[8:9]
    v_add_u32 v6, 4608, v6
    global_load_dword v145, v6, s[8:9]
    v_add_u32 v6, 4608, v6
    global_load_dword v146, v6, s[8:9]
    v_add_u32 v6, 4608, v6
    global_load_dword v147, v6, s[8:9]
    v_add_u32 v6, 4608, v6
    global_load_dword v148, v6, s[8:9]
    v_add_u32 v6, 4608, v6
    global_load_dword v149, v6, s[8:9]
    v_add_u32 v6, 4608, v6
    global_load_dword v150, v6, s[8:9]
    v_add_u32 v6, 4608, v6
    global_load_dword v151, v6, s[8:9]
    v_add_u32 v6, 4608, v6
    s_waitcnt vmcnt(0)
    v_add_f32 v7, v7, v48
    v_add_f32 v7, v7, v49
    v_add_f32 v7, v7, v50
    v_add_f32 v7, v7, v51
    v_add_f32 v7, v7, v52
    v_add_f32 v7, v7, v53
    v_add_f32 v7, v7, v54
    v_add_f32 v7, v7, v55
    v_add_f32 v7, v7, v56
    v_add_f32 v7, v7, v57
    v_add_f32 v7, v7, v58
    v_add_f32 v7, v7, v59
    v_add_f32 v7, v7, v60
    v_add_f32 v7, v7, v61
    v_add_f32 v7, v7, v62
    v_add_f32 v7, v7, v63
    v_add_f32 v7, v7, v64
    v_add_f32 v7, v7, v65
    v_add_f32 v7, v7, v66
    v_add_f32 v7, v7, v67
    v_add_f32 v7, v7, v68
    v_add_f32 v7, v7, v69
    v_add_f32 v7, v7, v70
    v_add_f32 v7, v7, v71
    v_add_f32 v7, v7, v72
    v_add_f32 v7, v7, v73
    v_add_f32 v7, v7, v74
    v_add_f32 v7, v7, v75
    v_add_f32 v7, v7, v76
    v_add_f32 v7, v7, v77
    v_add_f32 v7, v7, v78
    v_add_f32 v7, v7, v79
    v_add_f32 v8, v8, v80
    v_add_f32 v8, v8, v81
    v_add_f32 v8, v8, v82
    v_add_f32 v8, v8, v83
    v_add_f32 v8, v8, v84
    v_add_f32 v8, v8, v85
    v_add_f32 v8, v8, v86
    v_add_f32 v8, v8, v87
    v_add_f32 v8, v8, v88
    v_add_f32 v8, v8, v89
    v_add_f32 v8, v8, v90
    v_add_f32 v8, v8, v91
    v_add_f32 v8, v8, v92
    v_add_f32 v8, v8, v93
    v_add_f32 v8, v8, v94
    v_add_f32 v8, v8, v95
    v_add_f32 v8, v8, v96
    v_add_f32 v8, v8, v97
    v_add_f32 v8, v8, v98
    v_add_f32 v8, v8, v99
    v_add_f32 v8, v8, v100
    v_add_f32 v8, v8, v101
    v_add_f32 v8, v8, v102
    v_add_f32 v8, v8, v103
    v_add_f32 v8, v8, v104
    v_add_f32 v8, v8, v105
    v_add_f32 v8, v8, v106
    v_add_f32 v8, v8, v107
    v_add_f32 v8, v8, v108
    v_add_f32 v8, v8, v109
    v_add_f32 v8, v8, v110
    v_add_f32 v8, v8, v111
    v_add_f32 v8, v8, v112
    v_add_f32 v8, v8, v113
    v_add_f32 v8, v8, v114
    v_add_f32 v8, v8, v115
    v_add_f32 v8, v8, v116
    v_add_f32 v8, v8, v117
    v_add_f32 v8, v8, v118
    v_add_f32 v8, v8, v119
    v_add_f32 v8, v8, v120
    v_add_f32 v8, v8, v121
    v_add_f32 v8, v8, v122
    v_add_f32 v8, v8, v123
    v_add_f32 v8, v8, v124
    v_add_f32 v8, v8, v125
    v_add_f32 v8, v8, v126
    v_add_f32 v8, v8, v127
    v_add_f32 v8, v8, v128
    v_add_f32 v8, v8, v129
    v_add_f32 v8, v8, v130
    v_add_f32 v8, v8, v131
    v_add_f32 v8, v8, v132
    v_add_f32 v8, v8, v133
    v_add_f32 v8, v8, v134
    v_add_f32 v8, v8, v135
    v_add_f32 v8, v8, v136
    v_add_f32 v8, v8, v137
    v_add_f32 v8, v8, v138
    v_add_f32 v8, v8, v139
    v_add_f32 v8, v8, v140
    v_add_f32 v8, v8, v141
    v_add_f32 v8, v8, v142
    v_add_f32 v8, v8, v143
    v_add_f32 v8, v8, v144
    v_add_f32 v8, v8, v145
    v_add_f32 v8, v8, v146
    v_add_f32 v8, v8, v147
    v_add_f32 v8, v8, v148
    v_add_f32 v8, v8, v149
    v_add_f32 v8, v8, v150
    v_add_f32 v8, v8, v151
    v_mov_b32 v9, 0
    v_lshlrev_b32 v16, 16, v16
    v_lshlrev_b32 v32, 16, v32
    v_mul_f32 v16, v16, v32
    v_cvt_pk_bf16_f32 v10, v16, v16
    v_and_b32 v16, 0xffff0000, v10
    v_add_f32 v9, v9, v16
    v_lshlrev_b32 v17, 16, v17
    v_lshlrev_b32 v33, 16, v33
    v_mul_f32 v17, v17, v33
    v_cvt_pk_bf16_f32 v10, v17, v17
    v_and_b32 v17, 0xffff0000, v10
    v_add_f32 v9, v9, v17
    v_lshlrev_b32 v18, 16, v18
    v_lshlrev_b32 v34, 16, v34
    v_mul_f32 v18, v18, v34
    v_cvt_pk_bf16_f32 v10, v18, v18
    v_and_b32 v18, 0xffff0000, v10
    v_add_f32 v9, v9, v18
    v_lshlrev_b32 v19, 16, v19
    v_lshlrev_b32 v35, 16, v35
    v_mul_f32 v19, v19, v35
    v_cvt_pk_bf16_f32 v10, v19, v19
    v_and_b32 v19, 0xffff0000, v10
    v_add_f32 v9, v9, v19
    v_lshlrev_b32 v20, 16, v20
    v_lshlrev_b32 v36, 16, v36
    v_mul_f32 v20, v20, v36
    v_cvt_pk_bf16_f32 v10, v20, v20
    v_and_b32 v20, 0xffff0000, v10
    v_add_f32 v9, v9, v20
    v_lshlrev_b32 v21, 16, v21
    v_lshlrev_b32 v37, 16, v37
    v_mul_f32 v21, v21, v37
    v_cvt_pk_bf16_f32 v10, v21, v21
    v_and_b32 v21, 0xffff0000, v10
    v_add_f32 v9, v9, v21
    v_lshlrev_b32 v22, 16, v22
    v_lshlrev_b32 v38, 16, v38
    v_mul_f32 v22, v22, v38
    v_cvt_pk_bf16_f32 v10, v22, v22
    v_and_b32 v22, 0xffff0000, v10
    v_add_f32 v9, v9, v22
    v_lshlrev_b32 v23, 16, v23
    v_lshlrev_b32 v39, 16, v39
    v_mul_f32 v23, v23, v39
    v_cvt_pk_bf16_f32 v10, v23, v23
    v_and_b32 v23, 0xffff0000, v10
    v_add_f32 v9, v9, v23
    v_lshlrev_b32 v24, 16, v24
    v_lshlrev_b32 v40, 16, v40
    v_mul_f32 v24, v24, v40
    v_cvt_pk_bf16_f32 v10, v24, v24
    v_and_b32 v24, 0xffff0000, v10
    v_add_f32 v9, v9, v24
    v_lshlrev_b32 v10, 2, v0
    ds_write_b32 v10, v9
    s_waitcnt lgkmcnt(0)
    s_barrier
    v_lshlrev_b32 v10, 8, v2
    v_mov_b32 v9, 0
    ds_read_b32 v48, v10 offset:0
    ds_read_b32 v49, v10 offset:4
    ds_read_b32 v50, v10 offset:8
    ds_read_b32 v51, v10 offset:12
    ds_read_b32 v52, v10 offset:16
    ds_read_b32 v53, v10 offset:20
    ds_read_b32 v54, v10 offset:24
    ds_read_b32 v55, v10 offset:28
    ds_read_b32 v56, v10 offset:32
    ds_read_b32 v57, v10 offset:36
    ds_read_b32 v58, v10 offset:40
    ds_read_b32 v59, v10 offset:44
    ds_read_b32 v60, v10 offset:48
    ds_read_b32 v61, v10 offset:52
    ds_read_b32 v62, v10 offset:56
    ds_read_b32 v63, v10 offset:60
    ds_read_b32 v64, v10 offset:64
    ds_read_b32 v65, v10 offset:68
    ds_read_b32 v66, v10 offset:72
    ds_read_b32 v67, v10 offset:76
    ds_read_b32 v68, v10 offset:80
    ds_read_b32 v69, v10 offset:84
    ds_read_b32 v70, v10 offset:88
    ds_read_b32 v71, v10 offset:92
    ds_read_b32 v72, v10 offset:96
    ds_read_b32 v73, v10 offset:100
    ds_read_b32 v74, v10 offset:104
    ds_read_b32 v75, v10 offset:108
    ds_read_b32 v76, v10 offset:112
    ds_read_b32 v77, v10 offset:116
    ds_read_b32 v78, v10 offset:120
    ds_read_b32 v79, v10 offset:124
    s_waitcnt lgkmcnt(0)
    v_add_f32 v9, v9, v48
    v_add_f32 v9, v9, v49
    v_add_f32 v9, v9, v50
    v_add_f32 v9, v9, v51
    v_add_f32 v9, v9, v52
    v_add_f32 v9, v9, v53
    v_add_f32 v9, v9, v54
    v_add_f32 v9, v9, v55
    v_add_f32 v9, v9, v56
    v_add_f32 v9, v9, v57
    v_add_f32 v9, v9, v58
    v_add_f32 v9, v9, v59
    v_add_f32 v9, v9, v60
    v_add_f32 v9, v9, v61
    v_add_f32 v9, v9, v62
    v_add_f32 v9, v9, v63
    v_add_f32 v9, v9, v64
    v_add_f32 v9, v9, v65
    v_add_f32 v9, v9, v66
    v_add_f32 v9, v9, v67
    v_add_f32 v9, v9, v68
    v_add_f32 v9, v9, v69
    v_add_f32 v9, v9, v70
    v_add_f32 v9, v9, v71
    v_add_f32 v9, v9, v72
    v_add_f32 v9, v9, v73
    v_add_f32 v9, v9, v74
    v_add_f32 v9, v9, v75
    v_add_f32 v9, v9, v76
    v_add_f32 v9, v9, v77
    v_add_f32 v9, v9, v78
    v_add_f32 v9, v9, v79
    ds_read_b32 v48, v10 offset:128
    ds_read_b32 v49, v10 offset:132
    ds_read_b32 v50, v10 offset:136
    ds_read_b32 v51, v10 offset:140
    ds_read_b32 v52, v10 offset:144
    ds_read_b32 v53, v10 offset:148
    ds_read_b32 v54, v10 offset:152
    ds_read_b32 v55, v10 offset:156
    ds_read_b32 v56, v10 offset:160
    ds_read_b32 v57, v10 offset:164
    ds_read_b32 v58, v10 offset:168
    ds_read_b32 v59, v10 offset:172
    ds_read_b32 v60, v10 offset:176
    ds_read_b32 v61, v10 offset:180
    ds_read_b32 v62, v10 offset:184
    ds_read_b32 v63, v10 offset:188
    ds_read_b32 v64, v10 offset:192
    ds_read_b32 v65, v10 offset:196
    ds_read_b32 v66, v10 offset:200
    ds_read_b32 v67, v10 offset:204
    ds_read_b32 v68, v10 offset:208
    ds_read_b32 v69, v10 offset:212
    ds_read_b32 v70, v10 offset:216
    ds_read_b32 v71, v10 offset:220
    ds_read_b32 v72, v10 offset:224
    ds_read_b32 v73, v10 offset:228
    ds_read_b32 v74, v10 offset:232
    ds_read_b32 v75, v10 offset:236
    ds_read_b32 v76, v10 offset:240
    ds_read_b32 v77, v10 offset:244
    ds_read_b32 v78, v10 offset:248
    ds_read_b32 v79, v10 offset:252
    s_waitcnt lgkmcnt(0)
    v_add_f32 v9, v9, v48
    v_add_f32 v9, v9, v49
    v_add_f32 v9, v9, v50
    v_add_f32 v9, v9, v51
    v_add_f32 v9, v9, v52
    v_add_f32 v9, v9, v53
    v_add_f32 v9, v9, v54
    v_add_f32 v9, v9, v55
    v_add_f32 v9, v9, v56
    v_add_f32 v9, v9, v57
    v_add_f32 v9, v9, v58
    v_add_f32 v9, v9, v59
    v_add_f32 v9, v9, v60
    v_add_f32 v9, v9, v61
    v_add_f32 v9, v9, v62
    v_add_f32 v9, v9, v63
    v_add_f32 v9, v9, v64
    v_add_f32 v9, v9, v65
    v_add_f32 v9, v9, v66
    v_add_f32 v9, v9, v67
    v_add_f32 v9, v9, v68
    v_add_f32 v9, v9, v69
    v_add_f32 v9, v9, v70
    v_add_f32 v9, v9, v71
    v_add_f32 v9, v9, v72
    v_add_f32 v9, v9, v73
    v_add_f32 v9, v9, v74
    v_add_f32 v9, v9, v75
    v_add_f32 v9, v9, v76
    v_add_f32 v9, v9, v77
    v_add_f32 v9, v9, v78
    v_add_f32 v9, v9, v79
    v_cvt_pk_bf16_f32 v10, v9, v9
    v_and_b32 v9, 0xffff0000, v10
    s_mov_b32 s34, 0xbfb8aa3b
    v_mul_f32 v10, s34, v9
    v_exp_f32 v10, v10
    s_nop 0
    v_add_f32 v10, 1.0, v10
    v_rcp_f32 v10, v10
    s_nop 0
    v_cvt_pk_bf16_f32 v11, v10, v10
    v_and_b32 v10, 0xffff0000, v11
    v_cvt_pk_bf16_f32 v11, v7, v7
    v_and_b32 v7, 0xffff0000, v11
    v_cvt_pk_bf16_f32 v11, v8, v8
    v_and_b32 v8, 0xffff0000, v11
    v_mul_f32 v12, v10, v7
    v_cvt_pk_bf16_f32 v11, v12, v12
    v_and_b32 v12, 0xffff0000, v11
    v_sub_f32 v13, 1.0, v10
    v_cvt_pk_bf16_f32 v11, v13, v13
    v_and_b32 v13, 0xffff0000, v11
    v_mul_f32 v13, v13, v8
    v_cvt_pk_bf16_f32 v11, v13, v13
    v_and_b32 v13, 0xffff0000, v11
    v_add_f32 v12, v12, v13
    v_cvt_pk_bf16_f32 v12, v12, v12
    s_lshl_b32 s35, s12, 7
    v_mul_u32_u24 v14, 1152, v2
    v_lshl_add_u32 v14, v1, 1, v14
    v_add_u32 v14, s35, v14
    global_store_short v14, v12, s[28:29]
Lo_end:
    s_endpgm
.section .rodata,"a"
.p2align 6
.amdhsa_kernel oproj_kernel
  .amdhsa_next_free_vgpr 152
  .amdhsa_next_free_sgpr 64
  .amdhsa_accum_offset 152
  .amdhsa_group_segment_fixed_size 0
  .amdhsa_kernarg_size 104
  .amdhsa_user_sgpr_count 2
  .amdhsa_user_sgpr_kernarg_segment_ptr 1
  .amdhsa_system_sgpr_workgroup_id_x 1
.end_amdhsa_kernel
.text
```
